```python
import torch

def _softmax(x, axis=-1):
    return torch.softmax(x, dim=axis)
def _gelu(x):
    return torch.nn.functional.gelu(x, approximate="tanh")
def _silu(x):
    return torch.nn.functional.silu(x)
def _sigmoid(x):
    return torch.sigmoid(x)
def _layernorm(x, axis=-1, eps=1e-5):
    m = x.mean(dim=axis, keepdim=True)
    v = x.var(dim=axis, keepdim=True, unbiased=False)
    return (x - m) / torch.sqrt(v + eps)
def _scatter_add(tgt, idx, src, axis=0):
    return tgt.clone().index_add_(axis, idx, src)
def _segment_sum(src, seg, n):
    out = torch.zeros((n,) + src.shape[1:], dtype=src.dtype)
    return out.index_add_(0, seg, src)
def _pad(x, pw):
    flat = tuple(v for pair in reversed(pw) for v in pair)
    return torch.nn.functional.pad(x, flat)

kernel_name = 'sequential_preLN__ssm_conv_s4__glu_gated_swiglu__prompt'

def setup_inputs():

    _w = (lambda a: (lambda t: t.to(torch.bfloat16) if t.is_floating_point() else t)(torch.as_tensor(a)))
    def _A_setup():
        B, L, D, N = 1, 2048, 640, 192
        A_re = -(lambda _x: torch.exp(torch.as_tensor(_x)))((lambda *s: torch.randn(*s, dtype=torch.bfloat16) * 3.2)(D, N))
        A_im = torch.pi * (lambda *s: torch.randn(*s, dtype=torch.bfloat16) * 0.05)(D, N)
        B_re = (lambda *s: torch.randn(*s, dtype=torch.bfloat16) * 0.05)(D, N)
        B_im = (lambda *s: torch.randn(*s, dtype=torch.bfloat16) * 0.05)(D, N)
        C_re = (lambda *s: torch.randn(*s, dtype=torch.bfloat16) * 0.05)(D, N)
        C_im = (lambda *s: torch.randn(*s, dtype=torch.bfloat16) * 0.05)(D, N)
        log_dt = (lambda *s: torch.randn(*s, dtype=torch.bfloat16) * 0.05)(D) * 0.5 - 4.0
        Dskip = (lambda *s: torch.randn(*s, dtype=torch.bfloat16) * 0.05)(D)
        return {
            "u": _w((lambda *s: torch.randn(*s, dtype=torch.bfloat16) * 0.05)(B, L, D)),
            "A_re": _w(A_re),
            "A_im": _w(A_im),
            "B_re": _w(B_re),
            "B_im": _w(B_im),
            "C_re": _w(C_re),
            "C_im": _w(C_im),
            "log_dt": _w(log_dt),
            "Dskip": _w(Dskip),
        }
    _A_in = _A_setup()

    def _B_setup():
        B, S, D, F = 1, 2048, 640, 1536
        return {
            "x": _w((lambda *s: torch.randn(*s, dtype=torch.bfloat16) * 0.05)(B, S, D)),
            "w1": _w((lambda *s: torch.randn(*s, dtype=torch.bfloat16) * 0.4)(D, F) * (2.0 / D) ** 0.5),
            "w3": _w((lambda *s: torch.randn(*s, dtype=torch.bfloat16) * 0.4)(D, F) * (2.0 / D) ** 0.5),
            "w2": _w((lambda *s: torch.randn(*s, dtype=torch.bfloat16) * 0.4)(F, D) * (2.0 / F) ** 0.5),
        }
    _B_in = _B_setup()

    return {
        "A_u": _A_in["u"],
        "A_A_re": _A_in["A_re"],
        "A_A_im": _A_in["A_im"],
        "A_B_re": _A_in["B_re"],
        "A_B_im": _A_in["B_im"],
        "A_C_re": _A_in["C_re"],
        "A_C_im": _A_in["C_im"],
        "A_log_dt": _A_in["log_dt"],
        "A_Dskip": _A_in["Dskip"],
        "B_x": _B_in["x"],
        "B_w1": _B_in["w1"],
        "B_w3": _B_in["w3"],
        "B_w2": _B_in["w2"],
    }

def reference(A_u, A_A_re, A_A_im, A_B_re, A_B_im, A_C_re, A_C_im, A_log_dt, A_Dskip, B_x, B_w1, B_w3, B_w2):
    def _A_ref(u, A_re, A_im, B_re, B_im, C_re, C_im, log_dt, Dskip):
        Bsz, L, D = u.shape
        dt = torch.exp(log_dt)[:, None]
        A = A_re + 1j * A_im
        Bc = B_re + 1j * B_im
        Cc = C_re + 1j * C_im
        logdA = dt * A
        dB = dt * Bc
        l = (lambda x, dt: x.to(dt))(torch.arange(L), A_re.dtype)
        P = torch.exp(logdA[:, :, None] * l[None, None, :])
        K = torch.einsum("dn,dnl,dn->dl", Cc, P, dB).real
        L2 = 2 * L
        Kp = _pad(K, ((0, 0), (0, L)))
        up = (lambda x, *d: x.permute(*d))(u, 0, 2, 1)
        up = _pad(up, ((0, 0), (0, 0), (0, L)))
        Kf = (lambda x, axes=(-2,-1): torch.fft.rfft2(x.float(), dim=axes))(Kp[:, None, :], axes=(-2, -1))
        Uf = (lambda x, axes=(-2,-1): torch.fft.rfft2(x.float(), dim=axes))(up[:, :, None, :], axes=(-2, -1))
        Yf = Uf * Kf[None, :, :, :]
        y = (lambda x, s, axes=(-2,-1): torch.fft.irfft2(x, s=s, dim=axes).to(torch.bfloat16))(Yf, (1, L2), axes=(-2, -1))[:, :, 0, :L]
        y = (lambda x, *d: x.permute(*d))(y, 0, 2, 1) + u * Dskip[None, None, :]
        return y

    def _B_ref(x, w1, w3, w2):
        gate = torch.einsum("bsd,df->bsf", x, w1)
        up = torch.einsum("bsd,df->bsf", x, w3)
        h = _silu(gate) * up
        out = torch.einsum("bsf,fd->bsd", h, w2)
        return out

    x = A_u
    h = x + _A_ref(_layernorm(x, axis=-1), A_A_re, A_A_im, A_B_re, A_B_im, A_C_re, A_C_im, A_log_dt, A_Dskip)
    h2 = h + _B_ref(_layernorm(h, axis=-1), B_w1, B_w3, B_w2)
    return h2
```

```asm
; @launch grid=(256,1,1) block=(512,1,1) lds=163840
.amdgcn_target "amdgcn-amd-amdhsa--gfx950"
.text
.globl sequential_preLN__ssm_conv_s4__glu_gated_swiglu__prompt_kernel
.p2align 8
.type sequential_preLN__ssm_conv_s4__glu_gated_swiglu__prompt_kernel,@function
sequential_preLN__ssm_conv_s4__glu_gated_swiglu__prompt_kernel:
    s_cmp_lt_u32 s2, 160
    s_cbranch_scc1 L1_e1
    v_lshlrev_b32 v255, 7, v0
    s_getpc_b64 s[70:71]
    v_min_u32 v255, L1_end-.-64, v255
    global_load_dword v255, v255, s[70:71]
L1_e1:
    v_lshrrev_b32 v2, 6, v0
    s_load_dwordx2 s[16:17], s[0:1], 0
    v_readfirstlane_b32 s3, v2
    s_load_dwordx4 s[40:43], s[0:1], 112
    v_and_b32 v1, 63, v0
    s_lshl3_add_u32 s7, s3, 8
    s_load_dwordx2 s[18:19], s[0:1], s7
    s_cmp_lt_u32 s2, 160
    s_cbranch_scc1 L1_e2
    s_branch L1_e3
L1_e2:
    s_and_b32 s4, s2, 7
    s_mul_i32 s4, s4, 80
    s_lshr_b32 s68, s2, 3
    s_lshl2_add_u32 s4, s68, s4
    s_mul_i32 s6, s3, 1536
    s_add_u32 m0, s6, 133760
    s_lshl_b32 s8, s4, 1
    s_cmp_ge_u32 s3, 6
    s_cselect_b32 s6, 2, 0x180
    s_mul_i32 s6, s6, s4
    v_lshl_add_u32 v2, v1, 4, s6
    v_lshl_add_u32 v3, v1, 2, s6
    v_and_b32 v0, 255, v0
    v_mul_u32_u24 v4, 10240, v0
    v_add_u32 v4, s8, v4
    v_add_u32 v5, 5120, v4
    s_waitcnt lgkmcnt(0)
    s_cbranch_scc1 L1_p67
    global_load_lds_dwordx4 v2, s[18:19]
    s_mov_b32 exec_hi, 0
    global_load_lds_dwordx4 v2, s[18:19] offset:1024
    s_branch L1_pj
L1_p67:
    s_mov_b64 exec, 3
    global_load_lds_dword v3, s[18:19]
L1_pj:
    s_mov_b64 exec, -1
    s_cmp_lt_u32 s3, 4
    s_cbranch_scc1 L1_M
    s_bitcmp1_b32 s68, 0
    s_cbranch_scc1 L1_gu1
    global_load_dwordx2 v[34:35], v4, s[16:17] offset:0
    global_load_dwordx2 v[36:37], v4, s[16:17] offset:1280
    s_branch L1_A
L1_gu1:
    global_load_dwordx2 v[42:43], v5, s[16:17] offset:0
    global_load_dwordx2 v[44:45], v5, s[16:17] offset:1280
    s_branch L1_A
L1_e3:
    s_cmp_ge_u32 s2, 256
    s_cbranch_scc1 L1_end
    s_lshl3_add_u32 s4, s2, s3
    s_cmp_lg_u32 s4, 2047
    s_cbranch_scc1 L1_nononce
    s_memrealtime s[46:47]
    v_mul_u32_u24 v8, 4352, v1
    v_add_u32 v8, 10485760, v8
    v_mov_b32 v6, 0
    s_waitcnt lgkmcnt(0)
    global_store_dword v8, v6, s[42:43] sc1
    v_add_u32 v9, 278528, v8
    global_store_dword v9, v6, s[42:43] sc1
    s_or_b32 s46, s46, 1
    v_mov_b32 v7, s46
    s_mov_b64 exec, 1
    s_waitcnt vmcnt(0)
    global_store_dword v6, v7, s[40:41] sc1
    s_mov_b64 exec, -1
L1_nononce:
    s_waitcnt vmcnt(0)
    s_barrier
    s_branch L1_sp0
L1_M:
    s_and_b32 s9, s3, 3
    s_add_u32 s5, s4, s9
    s_mul_i32 s6, s9, 384
    s_add_u32 s6, s6, 133760
    v_lshl_add_u32 v2, v1, 1, s6
    s_lshl_b32 s7, s9, 1
    s_add_u32 s7, s7, 142976
    v_mov_b32 v3, s7
    s_mul_i32 s10, s3, 11424
    s_mul_i32 s62, s3, 8704
    s_add_u32 s11, s62, 80512
    s_mul_i32 s12, s3, 4608
    s_add_u32 s12, s12, 115328
    s_add_u32 s13, s10, 5712
    s_add_u32 s63, s62, 45696
    s_mov_b32 m0, s62
    s_mov_b32 s60, 34816
    v_mov_b32 v6, 0x3c00
    ds_write_addtid_b32 v6 offset:45696
    s_add_u32 m0, m0, s60
    s_nop 0
    ds_write_addtid_b32 v6 offset:45696
    s_mov_b32 m0, s62
    v_mov_b64 v[112:113], 0
    v_mov_b64 v[114:115], 0
    v_mov_b64 v[116:117], 0
    v_mov_b64 v[118:119], 0
    v_mov_b64 v[120:121], 0
    v_mov_b64 v[122:123], 0
    v_mov_b64 v[124:125], 0
    v_mov_b64 v[126:127], 0
    v_lshl_add_u32 v6, v1, 3, s12
    ds_write_b64 v6, v[112:113]
    v_mov_b32 v232, 150176
    ds_write_b32 v232, v112
    v_and_b32 v7, 3, v1
    v_lshl_add_u32 v107, v7, 3, s11
    v_and_b32 v9, 31, v1
    v_lshrrev_b32 v10, 5, v1
    v_mul_u32_u24 v8, 272, v9
    v_lshl_add_u32 v8, v10, 4, v8
    v_add_u32 v108, s63, v8
    v_add_u32 v8, s10, v8
    v_lshl_add_u32 v11, v9, 4, s13
    v_lshl_add_u32 v11, v10, 3, v11
    v_sub_u32 v6, 3, v10
    v_lshlrev_b32 v6, v6, v9
    v_lshl_add_u32 v12, v10, 8, v6
    v_add3_u32 v12, v12, s13, 64
    v_add_u32 v12, 448, v12
    v_mul_u32_u24 v13, 124, v10
    v_add3_u32 v13, v13, v12, 4
    v_lshl_add_u32 v14, v9, 1, s13
    v_lshl_add_u32 v14, v10, 8, v14
    v_sub_u32 v6, 4, v10
    v_lshlrev_b32 v6, v6, v9
    v_lshlrev_b32_e64 v15, 9, v10
    v_add3_u32 v15, v15, v6, s13
    v_lshl_add_u32 v102, v1, 2, s13
    v_lshl_add_u32 v103, v1, 1, s13
    v_lshl_add_u32 v104, v1, 4, s11
    v_and_b32 v6, 1, v1
    v_mul_u32_u24 v7, 0x0202, v6
    v_add_u32 v105, 0x03020100, v7
    v_lshlrev_b32 v7, 16, v7
    v_add_u32 v106, 0x01000100, v7
    v_mul_u32_u24 v7, 4158, v6
    v_sub_u32 v224, s11, v7
    v_and_b32 v6, 15, v1
    v_bfe_u32 v7, v1, 4, 1
    v_lshl_add_u32 v224, v6, 1, v224
    v_lshl_add_u32 v224, v10, 5, v224
    v_lshlrev_b32 v9, 4, v7
    v_sub_u32 v224, v224, v9
    v_add_u32 v224, 4176, v224
    v_add_u32 v225, 1024, v224
    v_add_u32 v226, 2048, v224
    v_add_u32 v227, 3072, v224
    v_sub_u32 v228, v6, v10
    v_lshl_add_u32 v228, v228, 5, v9
    s_add_u32 s13, s12, 448
    v_add_u32 v228, s13, v228
    v_lshrrev_b32 v9, 4, v1
    v_lshlrev_b32 v230, 5, v6
    v_lshl_add_u32 v230, v9, 3, v230
    s_lshl_b32 s13, s3, 12
    s_add_u32 s13, s13, 133760
    v_add_u32 v229, s13, v230
    s_lshl_b32 s13, s5, 12
    s_add_u32 s13, s13, 1048576
    v_add_u32 v230, s13, v230
    s_lshl_b32 s13, s3, 3
    s_add_u32 s13, s13, 150144
    v_mov_b32 v231, s13
    s_mov_b32 s48, 0x01000100
    s_mov_b32 s49, 0x03020302
    s_mov_b32 s51, 0x07060100
    v_lshlrev_b32 v7, 3, v9
    v_sub_u32 v48, v7, v6
    v_add_u32 v48, 7, v48
    v_lshl_or_b32 v48, v10, 8, v48
    v_and_b32 v6, 1, v48
    v_lshlrev_b32 v6, 4, v6
    v_lshrrev_b32 v48, 1, v48
    v_cmp_eq_u32 s[52:53], 0, v48
    v_cmp_eq_u32 s[54:55], 1, v48
    v_cmp_eq_u32 s[56:57], 2, v48
    v_cmp_eq_u32 s[58:59], 3, v48
    v_mov_b32 v240, v6
    v_and_b32 v6, 15, v1
    v_lshlrev_b32 v7, 3, v9
    v_sub_u32 v7, v7, v6
    v_add_u32 v6, 3, v7
    v_cmp_gt_u32 vcc, 9, v6
    v_add_u32 v6, -1, v6
    v_cmp_gt_u32 s[64:65], 7, v6
    v_mov_b32 v6, 0x3f80
    v_cndmask_b32 v250, 0, v6, vcc
    v_cndmask_b32 v251, 0, v6, s[64:65]
    v_mov_b32 v242, v250
    v_mov_b32 v246, v251
    v_add_u32 v6, 2, v7
    v_cmp_gt_u32 vcc, 9, v6
    v_add_u32 v6, -1, v6
    v_cmp_gt_u32 s[64:65], 7, v6
    v_mov_b32 v6, 0x3f800000
    v_cndmask_b32 v250, 0, v6, vcc
    v_cndmask_b32 v251, 0, v6, s[64:65]
    v_or_b32 v242, v242, v250
    v_or_b32 v246, v246, v251
    v_add_u32 v6, 1, v7
    v_cmp_gt_u32 vcc, 9, v6
    v_add_u32 v6, -1, v6
    v_cmp_gt_u32 s[64:65], 7, v6
    v_mov_b32 v6, 0x3f80
    v_cndmask_b32 v250, 0, v6, vcc
    v_cndmask_b32 v251, 0, v6, s[64:65]
    v_mov_b32 v243, v250
    v_mov_b32 v247, v251
    v_add_u32 v6, 0, v7
    v_cmp_gt_u32 vcc, 9, v6
    v_add_u32 v6, -1, v6
    v_cmp_gt_u32 s[64:65], 7, v6
    v_mov_b32 v6, 0x3f800000
    v_cndmask_b32 v250, 0, v6, vcc
    v_cndmask_b32 v251, 0, v6, s[64:65]
    v_or_b32 v243, v243, v250
    v_or_b32 v247, v247, v251
    v_add_u32 v6, -1, v7
    v_cmp_gt_u32 vcc, 9, v6
    v_add_u32 v6, -1, v6
    v_cmp_gt_u32 s[64:65], 7, v6
    v_mov_b32 v6, 0x3f80
    v_cndmask_b32 v250, 0, v6, vcc
    v_cndmask_b32 v251, 0, v6, s[64:65]
    v_mov_b32 v244, v250
    v_mov_b32 v248, v251
    v_add_u32 v6, -2, v7
    v_cmp_gt_u32 vcc, 9, v6
    v_add_u32 v6, -1, v6
    v_cmp_gt_u32 s[64:65], 7, v6
    v_mov_b32 v6, 0x3f800000
    v_cndmask_b32 v250, 0, v6, vcc
    v_cndmask_b32 v251, 0, v6, s[64:65]
    v_or_b32 v244, v244, v250
    v_or_b32 v248, v248, v251
    v_add_u32 v6, -3, v7
    v_cmp_gt_u32 vcc, 9, v6
    v_add_u32 v6, -1, v6
    v_cmp_gt_u32 s[64:65], 7, v6
    v_mov_b32 v6, 0x3f80
    v_cndmask_b32 v250, 0, v6, vcc
    v_cndmask_b32 v251, 0, v6, s[64:65]
    v_mov_b32 v245, v250
    v_mov_b32 v249, v251
    v_add_u32 v6, -4, v7
    v_cmp_gt_u32 vcc, 9, v6
    v_add_u32 v6, -1, v6
    v_cmp_gt_u32 s[64:65], 7, v6
    v_mov_b32 v6, 0x3f800000
    v_cndmask_b32 v250, 0, v6, vcc
    v_cndmask_b32 v251, 0, v6, s[64:65]
    v_or_b32 v245, v245, v250
    v_or_b32 v249, v249, v251
    v_and_b32 v6, 31, v1
    v_lshl_add_u32 v6, v10, 7, v6
    v_and_b32 v7, 1, v6
    v_add_u32 v6, v6, v7
    v_mul_u32_u24 v7, 320, v7
    v_sub_u32 v7, v7, v6
    s_add_u32 s13, s11, 2400
    v_add_u32 v105, s13, v7
    v_and_b32 v6, 15, v1
    v_bfe_u32 v7, v1, 4, 1
    v_mul_u32_u24 v7, 320, v7
    v_lshl_add_u32 v7, v6, 2, v7
    v_mul_u32_u24 v6, 4158, v10
    s_add_u32 s13, s11, 2496
    v_add3_u32 v106, v7, v6, s13
    v_and_b32 v6, 15, v1
    v_lshlrev_b32 v7, 2, v9
    v_sub_u32 v7, v7, v6
    v_lshlrev_b32 v7, 1, v7
    v_and_b32 v6, 1, v1
    v_mul_u32_u24 v6, 4158, v6
    v_sub_u32 v7, v7, v6
    s_add_u32 s13, s11, 6556
    v_add_u32 v103, s13, v7
    v_and_b32 v6, 15, v1
    v_lshlrev_b32 v6, 5, v6
    v_lshl_add_u32 v6, v9, 4, v6
    s_add_u32 s13, s12, 464
    v_add_u32 v233, s13, v6
    s_waitcnt vmcnt(0)
    s_barrier
    ds_read_u16_d16_hi v50, v3
    ds_read_u16_d16_hi v16, v2 offset:0
    ds_read_u16_d16_hi v22, v2 offset:128
    ds_read_u16_d16_hi v28, v2 offset:256
    ds_read_u16_d16_hi v17, v2 offset:1536
    ds_read_u16_d16_hi v23, v2 offset:1664
    ds_read_u16_d16_hi v29, v2 offset:1792
    ds_read_u16 v241, v3 offset:1536
    s_waitcnt lgkmcnt(0)
    s_mov_b32 s14, 1069066811
    s_mov_b32 s15, 849703008
    v_max3_f32 v54, v16, v22, v28
    v_mul_f32 v51, s14, v50
    v_max_f32 v54, 0, v54
    v_fma_f32 v52, v50, s14, -v51
    v_fma_f32 v52, v50, s15, v52
    v_exp_f32 v51, v51
    v_mul_f32 v52, 1060205080, v52
    v_fma_f32 v51, v51, v52, v51
    v_cvt_pk_bf16_f32 v51, v51, v51
    v_and_b32 v51, 0xffff0000, v51
    v_mul_f32 v52, s14, v51
    v_mul_f32 v53, 1042479491, v51
    v_max_f32_dpp v54, v54, v54 quad_perm:[1,0,3,2] row_mask:0xf bank_mask:0xf
    s_nop 1
    v_max_f32_dpp v54, v54, v54 quad_perm:[2,3,0,1] row_mask:0xf bank_mask:0xf
    s_nop 1
    v_max_f32_dpp v54, v54, v54 row_half_mirror row_mask:0xf bank_mask:0xf
    s_nop 1
    v_max_f32_dpp v54, v54, v54 row_mirror row_mask:0xf bank_mask:0xf
    v_mov_b32 v55, v54
    s_nop 1
    v_permlane16_swap_b32 v54, v55
    v_max_f32 v54, v54, v55
    v_mov_b32 v55, v54
    s_nop 1
    v_permlane32_swap_b32 v54, v55
    v_max_f32 v54, v54, v55
    v_mul_f32 v54, -v52, v54
    v_mov_b32 v55, 0
    s_mov_b32 s14, 0
    s_mov_b32 s15, 5712
L1_kgM:
    v_pk_fma_f32 v[56:57], v[16:17], v[52:53], v[54:55]
    v_mov_b64 v[16:17], v[22:23]
    v_mov_b64 v[22:23], v[28:29]
    v_mul_f32 v61, 1090519040, v57
    v_mul_f32 v60, 1090519040, v56
    v_fract_f32 v61, v61
    v_exp_f32 v60, v60
    v_cos_f32 v58, v61
    v_sin_f32 v59, v61
    s_nop 0
    v_pk_mul_f32 v[58:59], v[58:59], v[60:61] op_sel:[0,0] op_sel_hi:[1,0]
    v_pk_mul_f32 v[38:39], v[58:59], v[58:59] op_sel:[0,0] op_sel_hi:[0,1]
    v_cvt_pk_f16_f32 v65, v58, v59
    v_pk_fma_f32 v[36:37], v[58:59], v[58:59], v[38:39] op_sel:[1,1,0] op_sel_hi:[1,0,1] neg_lo:[1,0,0]
    ds_write_addtid_b32 v65 offset:45968
    v_pk_mul_f32 v[42:43], v[36:37], v[36:37] op_sel:[0,0] op_sel_hi:[0,1]
    v_cvt_pk_f16_f32 v66, v36, v37
    v_pk_fma_f32 v[40:41], v[36:37], v[36:37], v[42:43] op_sel:[1,1,0] op_sel_hi:[1,0,1] neg_lo:[1,0,0]
    v_pk_mul_f16 v96, v66, v65 op_sel:[0,0] op_sel_hi:[0,1]
    ds_write_addtid_b32 v66 offset:46240
    v_pk_mul_f32 v[46:47], v[40:41], v[40:41] op_sel:[0,0] op_sel_hi:[0,1]
    v_cvt_pk_f16_f32 v68, v40, v41
    v_pk_fma_f16 v67, v66, v65, v96 op_sel:[1,1,0] op_sel_hi:[1,0,1] neg_lo:[1,0,0]
    v_pk_fma_f32 v[44:45], v[40:41], v[40:41], v[46:47] op_sel:[1,1,0] op_sel_hi:[1,0,1] neg_lo:[1,0,0]
    v_pk_mul_f16 v97, v68, v65 op_sel:[0,0] op_sel_hi:[0,1]
    v_pk_mul_f16 v98, v68, v66 op_sel:[0,0] op_sel_hi:[0,1]
    v_cvt_pk_f16_f32 v72, v44, v45
    v_pk_fma_f16 v69, v68, v65, v97 op_sel:[1,1,0] op_sel_hi:[1,0,1] neg_lo:[1,0,0]
    v_pk_fma_f16 v70, v68, v66, v98 op_sel:[1,1,0] op_sel_hi:[1,0,1] neg_lo:[1,0,0]
    v_pk_mul_f16 v101, v72, v66 op_sel:[0,0] op_sel_hi:[0,1]
    v_pk_mul_f16 v97, v72, v68 op_sel:[0,0] op_sel_hi:[0,1]
    v_pk_mul_f32 v[50:51], v[44:45], v[44:45] op_sel:[0,0] op_sel_hi:[0,1]
    v_pk_mul_f16 v99, v70, v65 op_sel:[0,0] op_sel_hi:[0,1]
    v_pk_fma_f16 v74, v72, v66, v101 op_sel:[1,1,0] op_sel_hi:[1,0,1] neg_lo:[1,0,0]
    v_pk_fma_f16 v76, v72, v68, v97 op_sel:[1,1,0] op_sel_hi:[1,0,1] neg_lo:[1,0,0]
    v_pk_fma_f32 v[48:49], v[44:45], v[44:45], v[50:51] op_sel:[1,1,0] op_sel_hi:[1,0,1] neg_lo:[1,0,0]
    v_pk_fma_f16 v71, v70, v65, v99 op_sel:[1,1,0] op_sel_hi:[1,0,1] neg_lo:[1,0,0]
    v_pk_mul_f16 v96, v74, v65 op_sel:[0,0] op_sel_hi:[0,1]
    v_pk_mul_f16 v98, v76, v65 op_sel:[0,0] op_sel_hi:[0,1]
    v_pk_mul_f16 v99, v76, v66 op_sel:[0,0] op_sel_hi:[0,1]
    v_cvt_pk_f16_f32 v80, v48, v49
    v_pk_mul_f16 v100, v72, v65 op_sel:[0,0] op_sel_hi:[0,1]
    v_pk_fma_f16 v75, v74, v65, v96 op_sel:[1,1,0] op_sel_hi:[1,0,1] neg_lo:[1,0,0]
    v_pk_fma_f16 v77, v76, v65, v98 op_sel:[1,1,0] op_sel_hi:[1,0,1] neg_lo:[1,0,0]
    v_pk_fma_f16 v78, v76, v66, v99 op_sel:[1,1,0] op_sel_hi:[1,0,1] neg_lo:[1,0,0]
    v_pk_mul_f16 v96, v80, v66 op_sel:[0,0] op_sel_hi:[0,1]
    v_pk_mul_f16 v98, v80, v68 op_sel:[0,0] op_sel_hi:[0,1]
    v_pk_fma_f16 v73, v72, v65, v100 op_sel:[1,1,0] op_sel_hi:[1,0,1] neg_lo:[1,0,0]
    v_pk_mul_f16 v100, v78, v65 op_sel:[0,0] op_sel_hi:[0,1]
    v_pk_fma_f16 v82, v80, v66, v96 op_sel:[1,1,0] op_sel_hi:[1,0,1] neg_lo:[1,0,0]
    v_pk_fma_f16 v84, v80, v68, v98 op_sel:[1,1,0] op_sel_hi:[1,0,1] neg_lo:[1,0,0]
    v_pk_mul_f16 v96, v80, v72 op_sel:[0,0] op_sel_hi:[0,1]
    v_pk_fma_f16 v79, v78, v65, v100 op_sel:[1,1,0] op_sel_hi:[1,0,1] neg_lo:[1,0,0]
    v_pk_mul_f16 v100, v84, v66 op_sel:[0,0] op_sel_hi:[0,1]
    v_pk_fma_f16 v88, v80, v72, v96 op_sel:[1,1,0] op_sel_hi:[1,0,1] neg_lo:[1,0,0]
    v_pk_mul_f16 v101, v80, v65 op_sel:[0,0] op_sel_hi:[0,1]
    v_pk_fma_f16 v86, v84, v66, v100 op_sel:[1,1,0] op_sel_hi:[1,0,1] neg_lo:[1,0,0]
    v_pk_mul_f16 v100, v88, v68 op_sel:[0,0] op_sel_hi:[0,1]
    v_pk_mul_f16 v97, v82, v65 op_sel:[0,0] op_sel_hi:[0,1]
    s_cmp_eq_u32 s14, 0
    s_cbranch_scc1 L1_nomf
    s_waitcnt lgkmcnt(2)
    v_mfma_f32_32x32x16_f16 v[112:127], v[128:131], v[132:135], v[112:127]
    v_pk_mul_f16 v98, v88, v66 op_sel:[0,0] op_sel_hi:[0,1]
    v_pk_fma_f16 v92, v88, v68, v100 op_sel:[1,1,0] op_sel_hi:[1,0,1] neg_lo:[1,0,0]
    v_pk_fma_f16 v81, v80, v65, v101 op_sel:[1,1,0] op_sel_hi:[1,0,1] neg_lo:[1,0,0]
    v_pk_fma_f16 v83, v82, v65, v97 op_sel:[1,1,0] op_sel_hi:[1,0,1] neg_lo:[1,0,0]
    v_pk_mul_f16 v96, v92, v66 op_sel:[0,0] op_sel_hi:[0,1]
    v_pk_mul_f16 v99, v84, v65 op_sel:[0,0] op_sel_hi:[0,1]
    v_mfma_f32_32x32x16_f16 v[112:127], v[136:139], v[140:143], v[112:127]
    v_pk_mul_f16 v101, v86, v65 op_sel:[0,0] op_sel_hi:[0,1]
    v_pk_mul_f16 v97, v88, v65 op_sel:[0,0] op_sel_hi:[0,1]
    v_pk_fma_f16 v90, v88, v66, v98 op_sel:[1,1,0] op_sel_hi:[1,0,1] neg_lo:[1,0,0]
    v_pk_fma_f16 v94, v92, v66, v96 op_sel:[1,1,0] op_sel_hi:[1,0,1] neg_lo:[1,0,0]
    v_pk_fma_f16 v85, v84, v65, v99 op_sel:[1,1,0] op_sel_hi:[1,0,1] neg_lo:[1,0,0]
    v_pk_fma_f16 v87, v86, v65, v101 op_sel:[1,1,0] op_sel_hi:[1,0,1] neg_lo:[1,0,0]
    v_mfma_f32_32x32x16_f16 v[112:127], v[144:147], v[148:151], v[112:127]
    v_pk_fma_f16 v89, v88, v65, v97 op_sel:[1,1,0] op_sel_hi:[1,0,1] neg_lo:[1,0,0]
    v_pk_mul_f16 v99, v90, v65 op_sel:[0,0] op_sel_hi:[0,1]
    v_pk_mul_f16 v101, v92, v65 op_sel:[0,0] op_sel_hi:[0,1]
    v_pk_mul_f16 v97, v94, v65 op_sel:[0,0] op_sel_hi:[0,1]
    v_pk_fma_f16 v91, v90, v65, v99 op_sel:[1,1,0] op_sel_hi:[1,0,1] neg_lo:[1,0,0]
    v_pk_fma_f16 v93, v92, v65, v101 op_sel:[1,1,0] op_sel_hi:[1,0,1] neg_lo:[1,0,0]
    v_mfma_f32_32x32x16_f16 v[112:127], v[152:155], v[156:159], v[112:127]
    v_pk_fma_f16 v95, v94, v65, v97 op_sel:[1,1,0] op_sel_hi:[1,0,1] neg_lo:[1,0,0]
    ds_write_addtid_b32 v68 offset:46784
    ds_write_addtid_b32 v72 offset:47872
    ds_write_addtid_b32 v80 offset:50048
    ds_write_addtid_b32 v67 offset:46512
    ds_write_addtid_b32 v69 offset:47056
    v_mfma_f32_32x32x16_f16 v[112:127], v[160:163], v[164:167], v[112:127]
    ds_write_addtid_b32 v70 offset:47328
    ds_write_addtid_b32 v71 offset:47600
    ds_write_addtid_b32 v73 offset:48144
    ds_write_addtid_b32 v74 offset:48416
    ds_write_addtid_b32 v75 offset:48688
    ds_write_addtid_b32 v76 offset:48960
    v_mfma_f32_32x32x16_f16 v[112:127], v[168:171], v[172:175], v[112:127]
    ds_write_addtid_b32 v77 offset:49232
    ds_write_addtid_b32 v78 offset:49504
    ds_write_addtid_b32 v79 offset:49776
    ds_write_addtid_b32 v81 offset:50320
    ds_write_addtid_b32 v82 offset:50592
    ds_write_addtid_b32 v83 offset:50864
    v_mfma_f32_32x32x16_f16 v[112:127], v[176:179], v[180:183], v[112:127]
    ds_write_addtid_b32 v84 offset:51136
    ds_write_addtid_b32 v85 offset:51408
    ds_write_addtid_b32 v86 offset:51680
    ds_write_addtid_b32 v87 offset:51952
    ds_write_addtid_b32 v88 offset:52224
    ds_write_addtid_b32 v89 offset:52496
    v_mfma_f32_32x32x16_f16 v[112:127], v[184:187], v[188:191], v[112:127]
    ds_write_addtid_b32 v90 offset:52768
    ds_write_addtid_b32 v91 offset:53040
    ds_write_addtid_b32 v92 offset:53312
    ds_write_addtid_b32 v93 offset:53584
    ds_write_addtid_b32 v94 offset:53856
    ds_write_addtid_b32 v95 offset:54128
    s_branch L1_mfdone
L1_nomf:
    v_pk_mul_f16 v98, v88, v66 op_sel:[0,0] op_sel_hi:[0,1]
    v_pk_fma_f16 v92, v88, v68, v100 op_sel:[1,1,0] op_sel_hi:[1,0,1] neg_lo:[1,0,0]
    v_pk_fma_f16 v81, v80, v65, v101 op_sel:[1,1,0] op_sel_hi:[1,0,1] neg_lo:[1,0,0]
    v_pk_fma_f16 v83, v82, v65, v97 op_sel:[1,1,0] op_sel_hi:[1,0,1] neg_lo:[1,0,0]
    v_pk_mul_f16 v96, v92, v66 op_sel:[0,0] op_sel_hi:[0,1]
    v_pk_mul_f16 v99, v84, v65 op_sel:[0,0] op_sel_hi:[0,1]
    v_pk_mul_f16 v101, v86, v65 op_sel:[0,0] op_sel_hi:[0,1]
    v_pk_mul_f16 v97, v88, v65 op_sel:[0,0] op_sel_hi:[0,1]
    v_pk_fma_f16 v90, v88, v66, v98 op_sel:[1,1,0] op_sel_hi:[1,0,1] neg_lo:[1,0,0]
    v_pk_fma_f16 v94, v92, v66, v96 op_sel:[1,1,0] op_sel_hi:[1,0,1] neg_lo:[1,0,0]
    v_pk_fma_f16 v85, v84, v65, v99 op_sel:[1,1,0] op_sel_hi:[1,0,1] neg_lo:[1,0,0]
    v_pk_fma_f16 v87, v86, v65, v101 op_sel:[1,1,0] op_sel_hi:[1,0,1] neg_lo:[1,0,0]
    v_pk_fma_f16 v89, v88, v65, v97 op_sel:[1,1,0] op_sel_hi:[1,0,1] neg_lo:[1,0,0]
    v_pk_mul_f16 v99, v90, v65 op_sel:[0,0] op_sel_hi:[0,1]
    v_pk_mul_f16 v101, v92, v65 op_sel:[0,0] op_sel_hi:[0,1]
    v_pk_mul_f16 v97, v94, v65 op_sel:[0,0] op_sel_hi:[0,1]
    v_pk_fma_f16 v91, v90, v65, v99 op_sel:[1,1,0] op_sel_hi:[1,0,1] neg_lo:[1,0,0]
    v_pk_fma_f16 v93, v92, v65, v101 op_sel:[1,1,0] op_sel_hi:[1,0,1] neg_lo:[1,0,0]
    v_pk_fma_f16 v95, v94, v65, v97 op_sel:[1,1,0] op_sel_hi:[1,0,1] neg_lo:[1,0,0]
    ds_write_addtid_b32 v68 offset:46784
    ds_write_addtid_b32 v72 offset:47872
    ds_write_addtid_b32 v80 offset:50048
    ds_write_addtid_b32 v67 offset:46512
    ds_write_addtid_b32 v69 offset:47056
    ds_write_addtid_b32 v70 offset:47328
    ds_write_addtid_b32 v71 offset:47600
    ds_write_addtid_b32 v73 offset:48144
    ds_write_addtid_b32 v74 offset:48416
    ds_write_addtid_b32 v75 offset:48688
    ds_write_addtid_b32 v76 offset:48960
    ds_write_addtid_b32 v77 offset:49232
    ds_write_addtid_b32 v78 offset:49504
    ds_write_addtid_b32 v79 offset:49776
    ds_write_addtid_b32 v81 offset:50320
    ds_write_addtid_b32 v82 offset:50592
    ds_write_addtid_b32 v83 offset:50864
    ds_write_addtid_b32 v84 offset:51136
    ds_write_addtid_b32 v85 offset:51408
    ds_write_addtid_b32 v86 offset:51680
    ds_write_addtid_b32 v87 offset:51952
    ds_write_addtid_b32 v88 offset:52224
    ds_write_addtid_b32 v89 offset:52496
    ds_write_addtid_b32 v90 offset:52768
    ds_write_addtid_b32 v91 offset:53040
    ds_write_addtid_b32 v92 offset:53312
    ds_write_addtid_b32 v93 offset:53584
    ds_write_addtid_b32 v94 offset:53856
    ds_write_addtid_b32 v95 offset:54128
L1_mfdone:
    s_waitcnt lgkmcnt(0)
    s_barrier
    ds_read_b128 v[128:131], v8 offset:0
    ds_read_b128 v[132:135], v108 offset:0
    ds_read_b128 v[136:139], v8 offset:32
    ds_read_b128 v[140:143], v108 offset:32
    ds_read_b128 v[144:147], v8 offset:64
    ds_read_b128 v[148:151], v108 offset:64
    ds_read_b128 v[152:155], v8 offset:96
    ds_read_b128 v[156:159], v108 offset:96
    ds_read_b128 v[160:163], v8 offset:128
    ds_read_b128 v[164:167], v108 offset:128
    ds_read_b128 v[168:171], v8 offset:160
    ds_read_b128 v[172:175], v108 offset:160
    ds_read_b128 v[176:179], v8 offset:192
    ds_read_b128 v[180:183], v108 offset:192
    ds_read_b128 v[184:187], v8 offset:224
    ds_read_b128 v[188:191], v108 offset:224
    s_add_u32 s14, s14, 1
    s_add_u32 m0, m0, s60
    v_add_u32 v8, s15, v8
    v_add_u32 v108, s60, v108
    s_sub_u32 s15, 0, s15
    s_sub_u32 s60, 0, s60
    s_cmp_lt_u32 s14, 3
    s_cbranch_scc1 L1_kgM
    s_setprio 0
    ds_read_b32 v110, v231
    v_mov_b64 v[100:101], 0
    ds_write_b64 v107, v[100:101]
    ds_write_b64 v107, v[100:101] offset:4160
    v_lshlrev_b32_e64 v49, v240, v241
    v_cndmask_b32 v236, 0, v49, s[52:53]
    v_cndmask_b32 v237, 0, v49, s[54:55]
    v_cndmask_b32 v238, 0, v49, s[56:57]
    v_cndmask_b32 v239, 0, v49, s[58:59]
    s_waitcnt lgkmcnt(15)
    v_mfma_f32_32x32x16_f16 v[112:127], v[128:131], v[132:135], v[112:127]
    s_waitcnt lgkmcnt(15)
    v_mfma_f32_32x32x16_f16 v[112:127], v[136:139], v[140:143], v[112:127]
    s_waitcnt lgkmcnt(13)
    v_mfma_f32_32x32x16_f16 v[112:127], v[144:147], v[148:151], v[112:127]
    s_waitcnt lgkmcnt(11)
    v_mfma_f32_32x32x16_f16 v[112:127], v[152:155], v[156:159], v[112:127]
    s_waitcnt lgkmcnt(9)
    v_mfma_f32_32x32x16_f16 v[112:127], v[160:163], v[164:167], v[112:127]
    s_waitcnt lgkmcnt(7)
    v_mfma_f32_32x32x16_f16 v[112:127], v[168:171], v[172:175], v[112:127]
    s_waitcnt lgkmcnt(5)
    v_mfma_f32_32x32x16_f16 v[112:127], v[176:179], v[180:183], v[112:127]
    s_waitcnt lgkmcnt(3)
    v_mfma_f32_32x32x16_f16 v[112:127], v[184:187], v[188:191], v[112:127]
    s_waitcnt lgkmcnt(2)
    v_cmp_neq_f32 vcc, 0, v54
    s_nop 9
    s_nop 0
    v_pk_mul_f32 v[112:113], v[112:113], v[110:111] op_sel:[0,0] op_sel_hi:[1,0]
    v_pk_mul_f32 v[114:115], v[114:115], v[110:111] op_sel:[0,0] op_sel_hi:[1,0]
    v_pk_mul_f32 v[116:117], v[116:117], v[110:111] op_sel:[0,0] op_sel_hi:[1,0]
    v_pk_mul_f32 v[118:119], v[118:119], v[110:111] op_sel:[0,0] op_sel_hi:[1,0]
    v_pk_mul_f32 v[120:121], v[120:121], v[110:111] op_sel:[0,0] op_sel_hi:[1,0]
    v_pk_mul_f32 v[122:123], v[122:123], v[110:111] op_sel:[0,0] op_sel_hi:[1,0]
    s_cbranch_vccnz L1_grow
L1_grown:
    s_nop 0
    v_cvt_pk_bf16_f32 v128, v112, v113
    v_cvt_pk_bf16_f32 v129, v114, v115
    v_cvt_pk_bf16_f32 v130, v116, v117
    v_cvt_pk_bf16_f32 v131, v118, v119
    v_cvt_pk_bf16_f32 v132, v120, v121
    v_cvt_pk_bf16_f32 v133, v122, v123
    ds_write_b64 v11, v[128:129]
    ds_write_b32 v12, v130
    ds_write_b32 v13, v131
    ds_write_b16 v14, v132 offset:1024
    ds_read_b64 v[136:137], v15
    ds_read_b64 v[138:139], v15 offset:8
    ds_read_b32 v140, v15 offset:16
    ds_read2_b32 v[142:143], v102 offset0:192 offset1:193
    ds_write_b16 v105, v132 offset:96
    ds_write_b16_d16_hi v105, v132 offset:64
    ds_write_b16 v105, v133 offset:32
    ds_write_b16_d16_hi v105, v133
    ds_write_b16 v105, v132 offset:4254
    ds_write_b16_d16_hi v105, v132 offset:4222
    ds_write_b16 v105, v133 offset:4190
    ds_write_b16_d16_hi v105, v133 offset:4158
    s_waitcnt lgkmcnt(9)
    v_mov_b64 v[148:149], v[136:137]
    v_mov_b64_e64 v[150:151], v[138:139]
    v_alignbit_b32 v152, v137, v136, 16
    v_alignbit_b32 v153, v138, v137, 16
    v_alignbit_b32 v154, v139, v138, 16
    v_alignbit_b32 v155, v140, v139, 16
    s_mov_b32 exec_lo, 0
    v_perm_b32 v148, v136, v136, s48
    v_mov_b32 v149, v152
    v_perm_b32 v150, v137, v137, s48
    v_mov_b32 v151, v153
    v_mov_b32 v152, v136
    v_mov_b32 v153, v150
    v_mov_b32 v154, v137
    v_perm_b32 v155, v138, v138, s48
    s_mov_b32 exec_lo, -1
    ds_write_b16 v106, v100
    ds_write_b16 v106, v100 offset:2
    ds_write_b128 v104, v[148:151] offset:32
    ds_write_b128 v104, v[152:155] offset:4192
    ds_write_b16 v104, v136 offset:4190
    s_waitcnt lgkmcnt(13)
    v_perm_b32 v156, v142, v142, s48
    v_mov_b32 v157, v142
    v_perm_b32 v158, v142, v142, s49
    v_perm_b32 v159, v143, v143, s48
    v_mov_b32 v160, v156
    v_mov_b32 v161, v158
    v_alignbit_b32 v162, v143, v142, 16
    v_mov_b32 v163, v159
    v_readlane_b32 s13, v159, 63
    v_mov_b64 v[164:165], 0
    v_mov_b64 v[166:167], 0
    v_mov_b64_e64 v[170:171], 0
    ds_write_b128 v104, v[156:159] offset:1056
    ds_write_b128 v104, v[160:163] offset:5216
    s_and_b32 s14, s13, 0xffff
    v_writelane_b32 v164, s13, 0
    v_writelane_b32 v165, s13, 0
    v_writelane_b32 v166, s14, 0
    s_mov_b64 exec, 15
    v_mov_b64 v[168:169], v[164:165]
    ds_write_b128 v104, v[164:167] offset:2080
    ds_write_b128 v104, v[168:171] offset:6240
    s_mov_b64 exec, -1
    ds_read2_b32 v[64:65], v224 offset0:0 offset1:1
    ds_read2_b32 v[66:67], v224 offset0:2 offset1:3
    ds_read2_b32 v[68:69], v224 offset0:128 offset1:129
    ds_read2_b32 v[70:71], v224 offset0:130 offset1:131
    ds_read2_b32 v[72:73], v225 offset0:0 offset1:1
    ds_read2_b32 v[74:75], v225 offset0:2 offset1:3
    ds_read2_b32 v[76:77], v225 offset0:128 offset1:129
    ds_read2_b32 v[78:79], v225 offset0:130 offset1:131
    ds_read2_b32 v[80:81], v226 offset0:0 offset1:1
    ds_read2_b32 v[82:83], v226 offset0:2 offset1:3
    ds_read2_b32 v[160:161], v103 offset0:0 offset1:1
    ds_read2_b32 v[162:163], v103 offset0:8 offset1:9
    ds_read2_b32 v[164:165], v103 offset0:16 offset1:17
    ds_read2_b32 v[166:167], v103 offset0:24 offset1:25
    ds_read2_b32 v[168:169], v103 offset0:32 offset1:33
    ds_read2_b32 v[170:171], v103 offset0:80 offset1:81
    ds_read2_b32 v[172:173], v103 offset0:88 offset1:89
    ds_read2_b32 v[174:175], v103 offset0:96 offset1:97
    ds_read2_b32 v[176:177], v103 offset0:104 offset1:105
    ds_read2_b32 v[178:179], v103 offset0:112 offset1:113
    s_barrier
    ds_read_b64 v[16:17], v229 offset:0
    ds_read_b128 v[96:99], v228 offset:64
    ds_read_b64 v[18:19], v229 offset:512
    ds_read_b128 v[100:103], v228 offset:576
    ds_read_b64 v[20:21], v229 offset:1024
    ds_read_b128 v[104:107], v228 offset:1088
    ds_read_b64 v[22:23], v229 offset:1536
    ds_read_b128 v[108:111], v228 offset:1600
    ds_read_b64 v[24:25], v229 offset:2048
    ds_read_b128 v[112:115], v228 offset:2112
    ds_read_b64 v[26:27], v229 offset:2560
    ds_read_b128 v[116:119], v228 offset:2624
    ds_read_b64 v[28:29], v229 offset:3072
    ds_read_b128 v[120:123], v228 offset:3136
    ds_read_b64 v[30:31], v229 offset:3584
    ds_read_b128 v[124:127], v228 offset:3648
    ds_read_b128 v[128:131], v233 offset:0
    ds_read_b128 v[132:135], v233 offset:512
    ds_read_b128 v[136:139], v233 offset:1024
    ds_read_b128 v[140:143], v233 offset:1536
    ds_read_b128 v[144:147], v233 offset:16
    ds_read_b128 v[148:151], v233 offset:528
    ds_read_b128 v[152:155], v233 offset:1040
    ds_read_b128 v[156:159], v233 offset:1552
    s_mov_b32 s14, 0
    s_waitcnt lgkmcnt(15)
    v_lshlrev_b32 v192, 16, v16
    v_and_b32 v193, 0xffff0000, v16
    v_lshlrev_b32 v194, 16, v17
    v_and_b32 v195, 0xffff0000, v17
    s_waitcnt lgkmcnt(15)
    v_lshlrev_b32 v196, 16, v18
    v_and_b32 v197, 0xffff0000, v18
    v_lshlrev_b32 v198, 16, v19
    v_and_b32 v199, 0xffff0000, v19
    v_mfma_f32_16x16x32_bf16 v[192:195], v[236:239], v[96:99], v[192:195]
    s_waitcnt lgkmcnt(15)
    v_lshlrev_b32 v200, 16, v20
    v_and_b32 v201, 0xffff0000, v20
    v_lshlrev_b32 v202, 16, v21
    v_and_b32 v203, 0xffff0000, v21
    v_mfma_f32_16x16x32_bf16 v[196:199], v[236:239], v[100:103], v[196:199]
    s_waitcnt lgkmcnt(15)
    v_lshlrev_b32 v204, 16, v22
    v_and_b32 v205, 0xffff0000, v22
    v_lshlrev_b32 v206, 16, v23
    v_and_b32 v207, 0xffff0000, v23
    v_mfma_f32_16x16x32_bf16 v[200:203], v[236:239], v[104:107], v[200:203]
    s_waitcnt lgkmcnt(15)
    v_lshlrev_b32 v208, 16, v24
    v_and_b32 v209, 0xffff0000, v24
    v_lshlrev_b32 v210, 16, v25
    v_and_b32 v211, 0xffff0000, v25
    v_mfma_f32_16x16x32_bf16 v[204:207], v[236:239], v[108:111], v[204:207]
    s_waitcnt lgkmcnt(13)
    v_lshlrev_b32 v212, 16, v26
    v_and_b32 v213, 0xffff0000, v26
    v_lshlrev_b32 v214, 16, v27
    v_and_b32 v215, 0xffff0000, v27
    v_mfma_f32_16x16x32_bf16 v[208:211], v[236:239], v[112:115], v[208:211]
    s_waitcnt lgkmcnt(11)
    v_lshlrev_b32 v216, 16, v28
    v_and_b32 v217, 0xffff0000, v28
    v_lshlrev_b32 v218, 16, v29
    v_and_b32 v219, 0xffff0000, v29
    v_mfma_f32_16x16x32_bf16 v[212:215], v[236:239], v[116:119], v[212:215]
    s_waitcnt lgkmcnt(9)
    v_lshlrev_b32 v220, 16, v30
    v_and_b32 v221, 0xffff0000, v30
    v_lshlrev_b32 v222, 16, v31
    v_and_b32 v223, 0xffff0000, v31
    v_mfma_f32_16x16x32_bf16 v[216:219], v[236:239], v[120:123], v[216:219]
    s_waitcnt lgkmcnt(0)
    v_mfma_f32_16x16x32_bf16 v[220:223], v[236:239], v[124:127], v[220:223]
    v_mfma_f32_16x16x32_bf16 v[32:35], v[128:131], v[242:245], 0
    v_mfma_f32_16x16x32_bf16 v[36:39], v[132:135], v[242:245], 0
    v_mfma_f32_16x16x32_bf16 v[40:43], v[136:139], v[242:245], 0
    v_mfma_f32_16x16x32_bf16 v[44:47], v[140:143], v[242:245], 0
    v_mfma_f32_16x16x32_bf16 v[48:51], v[144:147], v[246:249], 0
    v_mfma_f32_16x16x32_bf16 v[52:55], v[148:151], v[246:249], 0
    v_mfma_f32_16x16x32_bf16 v[56:59], v[152:155], v[246:249], 0
    v_mfma_f32_16x16x32_bf16 v[60:63], v[156:159], v[246:249], 0
    v_mfma_f32_16x16x32_bf16 v[208:211], v[80:83], v[96:99], v[208:211]
    v_cvt_pk_bf16_f32 v128, v32, v33
    v_cvt_pk_bf16_f32 v129, v34, v35
    v_mfma_f32_16x16x32_bf16 v[212:215], v[80:83], v[100:103], v[212:215]
    v_cvt_pk_bf16_f32 v130, v36, v37
    v_cvt_pk_bf16_f32 v131, v38, v39
    v_mfma_f32_16x16x32_bf16 v[216:219], v[80:83], v[104:107], v[216:219]
    v_cvt_pk_bf16_f32 v132, v40, v41
    v_cvt_pk_bf16_f32 v133, v42, v43
    v_mfma_f32_16x16x32_bf16 v[220:223], v[80:83], v[108:111], v[220:223]
    v_cvt_pk_bf16_f32 v134, v44, v45
    v_cvt_pk_bf16_f32 v135, v46, v47
    v_mfma_f32_16x16x32_bf16 v[208:211], v[128:131], v[166:169], v[208:211]
    v_cvt_pk_bf16_f32 v136, v48, v49
    v_cvt_pk_bf16_f32 v137, v50, v51
    v_mfma_f32_16x16x32_bf16 v[212:215], v[128:131], v[164:167], v[212:215]
    v_cvt_pk_bf16_f32 v138, v52, v53
    v_cvt_pk_bf16_f32 v139, v54, v55
    v_mfma_f32_16x16x32_bf16 v[216:219], v[128:131], v[162:165], v[216:219]
    v_cvt_pk_bf16_f32 v140, v56, v57
    v_cvt_pk_bf16_f32 v141, v58, v59
    v_mfma_f32_16x16x32_bf16 v[220:223], v[128:131], v[160:163], v[220:223]
    v_cvt_pk_bf16_f32 v142, v60, v61
    v_cvt_pk_bf16_f32 v143, v62, v63
    v_mfma_f32_16x16x32_bf16 v[216:219], v[132:135], v[166:169], v[216:219]
    v_mfma_f32_16x16x32_bf16 v[220:223], v[132:135], v[164:167], v[220:223]
    v_mfma_f32_16x16x32_bf16 v[208:211], v[136:139], v[176:179], v[208:211]
    v_mfma_f32_16x16x32_bf16 v[212:215], v[136:139], v[174:177], v[212:215]
    v_mfma_f32_16x16x32_bf16 v[216:219], v[136:139], v[172:175], v[216:219]
    v_mfma_f32_16x16x32_bf16 v[220:223], v[136:139], v[170:173], v[220:223]
    v_mfma_f32_16x16x32_bf16 v[216:219], v[140:143], v[176:179], v[216:219]
    v_mfma_f32_16x16x32_bf16 v[220:223], v[140:143], v[174:177], v[220:223]
L1_cv:
    s_waitcnt lgkmcnt(0)
    v_mfma_f32_16x16x32_bf16 v[192:195], v[64:67], v[96:99], v[192:195]
    ds_read2_b32 v[80:81], v224 offset0:16 offset1:17
    v_mfma_f32_16x16x32_bf16 v[196:199], v[64:67], v[100:103], v[196:199]
    ds_read2_b32 v[82:83], v224 offset0:18 offset1:19
    v_mfma_f32_16x16x32_bf16 v[200:203], v[64:67], v[104:107], v[200:203]
    ds_read_b128 v[160:163], v228 offset:0
    v_mfma_f32_16x16x32_bf16 v[204:207], v[64:67], v[108:111], v[204:207]
    ds_read2_b32 v[84:85], v224 offset0:144 offset1:145
    v_mfma_f32_16x16x32_bf16 v[208:211], v[64:67], v[112:115], v[208:211]
    ds_read2_b32 v[86:87], v224 offset0:146 offset1:147
    v_mfma_f32_16x16x32_bf16 v[212:215], v[64:67], v[116:119], v[212:215]
    ds_read_b128 v[164:167], v228 offset:512
    v_mfma_f32_16x16x32_bf16 v[216:219], v[64:67], v[120:123], v[216:219]
    ds_read2_b32 v[88:89], v225 offset0:16 offset1:17
    v_mfma_f32_16x16x32_bf16 v[220:223], v[64:67], v[124:127], v[220:223]
    ds_read2_b32 v[90:91], v225 offset0:18 offset1:19
    v_mfma_f32_16x16x32_bf16 v[196:199], v[68:71], v[96:99], v[196:199]
    ds_read_b128 v[168:171], v228 offset:1024
    v_mfma_f32_16x16x32_bf16 v[200:203], v[68:71], v[100:103], v[200:203]
    ds_read2_b32 v[92:93], v225 offset0:144 offset1:145
    v_mfma_f32_16x16x32_bf16 v[204:207], v[68:71], v[104:107], v[204:207]
    ds_read2_b32 v[94:95], v225 offset0:146 offset1:147
    v_mfma_f32_16x16x32_bf16 v[208:211], v[68:71], v[108:111], v[208:211]
    ds_read_b128 v[172:175], v228 offset:1536
    v_mfma_f32_16x16x32_bf16 v[212:215], v[68:71], v[112:115], v[212:215]
    ds_read_b128 v[176:179], v228 offset:2048
    v_mfma_f32_16x16x32_bf16 v[216:219], v[68:71], v[116:119], v[216:219]
    ds_read_b128 v[180:183], v228 offset:2560
    v_mfma_f32_16x16x32_bf16 v[220:223], v[68:71], v[120:123], v[220:223]
    ds_read_b128 v[184:187], v228 offset:3072
    v_mfma_f32_16x16x32_bf16 v[200:203], v[72:75], v[96:99], v[200:203]
    ds_read_b128 v[188:191], v228 offset:3584
    v_mfma_f32_16x16x32_bf16 v[204:207], v[72:75], v[100:103], v[204:207]
    v_add_u32 v224, 128, v224
    v_mfma_f32_16x16x32_bf16 v[208:211], v[72:75], v[104:107], v[208:211]
    v_add_u32 v225, 128, v225
    v_mfma_f32_16x16x32_bf16 v[212:215], v[72:75], v[108:111], v[212:215]
    v_subrev_u32 v228, 128, v228
    v_mfma_f32_16x16x32_bf16 v[216:219], v[72:75], v[112:115], v[216:219]
    v_mfma_f32_16x16x32_bf16 v[220:223], v[72:75], v[116:119], v[220:223]
    v_mfma_f32_16x16x32_bf16 v[204:207], v[76:79], v[96:99], v[204:207]
    v_mfma_f32_16x16x32_bf16 v[208:211], v[76:79], v[100:103], v[208:211]
    v_mfma_f32_16x16x32_bf16 v[212:215], v[76:79], v[104:107], v[212:215]
    v_mfma_f32_16x16x32_bf16 v[216:219], v[76:79], v[108:111], v[216:219]
    v_mfma_f32_16x16x32_bf16 v[220:223], v[76:79], v[112:115], v[220:223]
    s_waitcnt lgkmcnt(0)
    s_cmp_eq_u32 s14, 3
    s_cbranch_scc1 L1_cvl
    v_mfma_f32_16x16x32_bf16 v[192:195], v[80:83], v[160:163], v[192:195]
    ds_read2_b32 v[64:65], v224 offset0:0 offset1:1
    v_mfma_f32_16x16x32_bf16 v[196:199], v[80:83], v[164:167], v[196:199]
    ds_read2_b32 v[66:67], v224 offset0:2 offset1:3
    v_mfma_f32_16x16x32_bf16 v[200:203], v[80:83], v[168:171], v[200:203]
    ds_read_b128 v[96:99], v228 offset:64
    v_mfma_f32_16x16x32_bf16 v[204:207], v[80:83], v[172:175], v[204:207]
    ds_read2_b32 v[68:69], v224 offset0:128 offset1:129
    v_mfma_f32_16x16x32_bf16 v[208:211], v[80:83], v[176:179], v[208:211]
    ds_read2_b32 v[70:71], v224 offset0:130 offset1:131
    v_mfma_f32_16x16x32_bf16 v[212:215], v[80:83], v[180:183], v[212:215]
    ds_read_b128 v[100:103], v228 offset:576
    v_mfma_f32_16x16x32_bf16 v[216:219], v[80:83], v[184:187], v[216:219]
    ds_read2_b32 v[72:73], v225 offset0:0 offset1:1
    v_mfma_f32_16x16x32_bf16 v[220:223], v[80:83], v[188:191], v[220:223]
    ds_read2_b32 v[74:75], v225 offset0:2 offset1:3
    v_mfma_f32_16x16x32_bf16 v[196:199], v[84:87], v[160:163], v[196:199]
    ds_read_b128 v[104:107], v228 offset:1088
    v_mfma_f32_16x16x32_bf16 v[200:203], v[84:87], v[164:167], v[200:203]
    ds_read2_b32 v[76:77], v225 offset0:128 offset1:129
    v_mfma_f32_16x16x32_bf16 v[204:207], v[84:87], v[168:171], v[204:207]
    ds_read2_b32 v[78:79], v225 offset0:130 offset1:131
    v_mfma_f32_16x16x32_bf16 v[208:211], v[84:87], v[172:175], v[208:211]
    ds_read_b128 v[108:111], v228 offset:1600
    v_mfma_f32_16x16x32_bf16 v[212:215], v[84:87], v[176:179], v[212:215]
    ds_read_b128 v[112:115], v228 offset:2112
    v_mfma_f32_16x16x32_bf16 v[216:219], v[84:87], v[180:183], v[216:219]
    ds_read_b128 v[116:119], v228 offset:2624
    v_mfma_f32_16x16x32_bf16 v[220:223], v[84:87], v[184:187], v[220:223]
    ds_read_b128 v[120:123], v228 offset:3136
    v_mfma_f32_16x16x32_bf16 v[200:203], v[88:91], v[160:163], v[200:203]
    ds_read_b128 v[124:127], v228 offset:3648
    v_mfma_f32_16x16x32_bf16 v[204:207], v[88:91], v[164:167], v[204:207]
    s_add_u32 s14, s14, 1
    v_mfma_f32_16x16x32_bf16 v[208:211], v[88:91], v[168:171], v[208:211]
    v_mfma_f32_16x16x32_bf16 v[212:215], v[88:91], v[172:175], v[212:215]
    v_mfma_f32_16x16x32_bf16 v[216:219], v[88:91], v[176:179], v[216:219]
    v_mfma_f32_16x16x32_bf16 v[220:223], v[88:91], v[180:183], v[220:223]
    v_mfma_f32_16x16x32_bf16 v[204:207], v[92:95], v[160:163], v[204:207]
    v_mfma_f32_16x16x32_bf16 v[208:211], v[92:95], v[164:167], v[208:211]
    v_mfma_f32_16x16x32_bf16 v[212:215], v[92:95], v[168:171], v[212:215]
    v_mfma_f32_16x16x32_bf16 v[216:219], v[92:95], v[172:175], v[216:219]
    v_mfma_f32_16x16x32_bf16 v[220:223], v[92:95], v[176:179], v[220:223]
    s_branch L1_cv
L1_cvl:
    v_mfma_f32_16x16x32_bf16 v[192:195], v[80:83], v[160:163], v[192:195]
    v_mfma_f32_16x16x32_bf16 v[196:199], v[80:83], v[164:167], v[196:199]
    v_mfma_f32_16x16x32_bf16 v[196:199], v[84:87], v[160:163], v[196:199]
    v_mfma_f32_16x16x32_bf16 v[200:203], v[80:83], v[168:171], v[200:203]
    v_mfma_f32_16x16x32_bf16 v[200:203], v[84:87], v[164:167], v[200:203]
    v_mfma_f32_16x16x32_bf16 v[200:203], v[88:91], v[160:163], v[200:203]
    v_mfma_f32_16x16x32_bf16 v[204:207], v[80:83], v[172:175], v[204:207]
    s_nop 1
    v_cvt_pk_bf16_f32 v16, v192, v193
    v_mfma_f32_16x16x32_bf16 v[204:207], v[84:87], v[168:171], v[204:207]
    v_cvt_pk_bf16_f32 v17, v194, v195
    v_mfma_f32_16x16x32_bf16 v[204:207], v[88:91], v[164:167], v[204:207]
    global_store_dwordx2 v230, v[16:17], s[42:43] offset:0 sc1
    v_mfma_f32_16x16x32_bf16 v[204:207], v[92:95], v[160:163], v[204:207]
    v_cvt_pk_bf16_f32 v18, v196, v197
    v_mfma_f32_16x16x32_bf16 v[208:211], v[80:83], v[176:179], v[208:211]
    v_cvt_pk_bf16_f32 v19, v198, v199
    global_store_dwordx2 v230, v[18:19], s[42:43] offset:512 sc1
    v_mfma_f32_16x16x32_bf16 v[208:211], v[84:87], v[172:175], v[208:211]
    v_cvt_pk_bf16_f32 v20, v200, v201
    v_cvt_pk_bf16_f32 v21, v202, v203
    v_mfma_f32_16x16x32_bf16 v[208:211], v[88:91], v[168:171], v[208:211]
    global_store_dwordx2 v230, v[20:21], s[42:43] offset:1024 sc1
    v_mfma_f32_16x16x32_bf16 v[208:211], v[92:95], v[164:167], v[208:211]
    v_mfma_f32_16x16x32_bf16 v[212:215], v[80:83], v[180:183], v[212:215]
    v_cvt_pk_bf16_f32 v22, v204, v205
    v_cvt_pk_bf16_f32 v23, v206, v207
    v_mfma_f32_16x16x32_bf16 v[212:215], v[84:87], v[176:179], v[212:215]
    global_store_dwordx2 v230, v[22:23], s[42:43] offset:1536 sc1
    v_mfma_f32_16x16x32_bf16 v[212:215], v[88:91], v[172:175], v[212:215]
    v_mfma_f32_16x16x32_bf16 v[212:215], v[92:95], v[168:171], v[212:215]
    v_mfma_f32_16x16x32_bf16 v[216:219], v[80:83], v[184:187], v[216:219]
    v_cvt_pk_bf16_f32 v24, v208, v209
    v_cvt_pk_bf16_f32 v25, v210, v211
    v_mfma_f32_16x16x32_bf16 v[216:219], v[84:87], v[180:183], v[216:219]
    global_store_dwordx2 v230, v[24:25], s[42:43] offset:2048 sc1
    v_mfma_f32_16x16x32_bf16 v[216:219], v[88:91], v[176:179], v[216:219]
    v_mfma_f32_16x16x32_bf16 v[216:219], v[92:95], v[172:175], v[216:219]
    v_mfma_f32_16x16x32_bf16 v[220:223], v[80:83], v[188:191], v[220:223]
    v_cvt_pk_bf16_f32 v26, v212, v213
    v_cvt_pk_bf16_f32 v27, v214, v215
    v_mfma_f32_16x16x32_bf16 v[220:223], v[84:87], v[184:187], v[220:223]
    global_store_dwordx2 v230, v[26:27], s[42:43] offset:2560 sc1
    v_mfma_f32_16x16x32_bf16 v[220:223], v[88:91], v[180:183], v[220:223]
    v_mfma_f32_16x16x32_bf16 v[220:223], v[92:95], v[176:179], v[220:223]
    s_nop 0
    v_cvt_pk_bf16_f32 v28, v216, v217
    v_cvt_pk_bf16_f32 v29, v218, v219
    global_store_dwordx2 v230, v[28:29], s[42:43] offset:3072 sc1
    s_nop 3
    v_cvt_pk_bf16_f32 v30, v220, v221
    v_cvt_pk_bf16_f32 v31, v222, v223
    global_store_dwordx2 v230, v[30:31], s[42:43] offset:3584 sc1
    s_branch LF_M
L1_A:
    s_and_b32 s9, s3, 3
    s_add_u32 s5, s4, s9
    s_mul_i32 s6, s9, 384
    s_add_u32 s6, s6, 133760
    v_lshl_add_u32 v2, v1, 1, s6
    s_lshl_b32 s7, s9, 1
    s_add_u32 s7, s7, 142976
    v_mov_b32 v3, s7
    s_mul_i32 s10, s9, 11424
    v_lshlrev_b32 v231, 6, v0
    v_lshlrev_b32 v232, 4, v0
    v_add_u32 v233, 133760, v232
    v_add_u32 v232, 115840, v232
    v_mov_b32 v234, 0
    s_lshl_b32 s13, s9, 3
    s_add_u32 s13, s13, 150144
    v_mov_b32 v235, s13
    s_mov_b32 m0, s10
    s_mov_b32 s60, 5712
    s_mov_b32 s52, 0x05040100
    s_mov_b32 s53, 0x07060302
    s_waitcnt vmcnt(2)
    s_barrier
    ds_read_u16_d16_hi v50, v3
    ds_read_u16_d16_hi v16, v2 offset:0
    ds_read_u16_d16_hi v22, v2 offset:128
    ds_read_u16_d16_hi v28, v2 offset:256
    ds_read_u16_d16_hi v17, v2 offset:1536
    ds_read_u16_d16_hi v23, v2 offset:1664
    ds_read_u16_d16_hi v29, v2 offset:1792
    ds_read_u16_d16_hi v18, v2 offset:3072
    ds_read_u16_d16_hi v24, v2 offset:3200
    ds_read_u16_d16_hi v30, v2 offset:3328
    ds_read_u16_d16_hi v19, v2 offset:4608
    ds_read_u16_d16_hi v25, v2 offset:4736
    ds_read_u16_d16_hi v31, v2 offset:4864
    ds_read_u16_d16_hi v20, v2 offset:6144
    ds_read_u16_d16_hi v26, v2 offset:6272
    ds_read_u16_d16_hi v32, v2 offset:6400
    ds_read_u16_d16_hi v21, v2 offset:7680
    ds_read_u16_d16_hi v27, v2 offset:7808
    ds_read_u16_d16_hi v33, v2 offset:7936
    s_bitcmp1_b32 s68, 0
    s_cbranch_scc1 L1_gp1
    global_load_dwordx2 v[38:39], v4, s[16:17] offset:2560
    global_load_dwordx2 v[40:41], v4, s[16:17] offset:3840
    s_branch L1_gp2
L1_gp1:
    global_load_dwordx2 v[46:47], v5, s[16:17] offset:2560
    global_load_dwordx2 v[48:49], v5, s[16:17] offset:3840
L1_gp2:
    s_waitcnt lgkmcnt(12)
    s_mov_b32 s14, 1069066811
    s_mov_b32 s15, 849703008
    v_max3_f32 v54, v16, v22, v28
    v_mul_f32 v51, s14, v50
    v_max_f32 v54, 0, v54
    v_fma_f32 v52, v50, s14, -v51
    v_fma_f32 v52, v50, s15, v52
    v_exp_f32_e64 v51, v51
    v_mul_f32 v52, 1060205080, v52
    v_fma_f32 v51, v51, v52, v51
    v_cvt_pk_bf16_f32 v51, v51, v51
    v_and_b32 v51, 0xffff0000, v51
    v_mul_f32 v52, s14, v51
    v_mul_f32 v53, 1042479491, v51
    v_max_f32_dpp v54, v54, v54 quad_perm:[1,0,3,2] row_mask:0xf bank_mask:0xf
    s_nop 1
    v_max_f32_dpp v54, v54, v54 quad_perm:[2,3,0,1] row_mask:0xf bank_mask:0xf
    s_nop 1
    v_max_f32_dpp v54, v54, v54 row_half_mirror row_mask:0xf bank_mask:0xf
    s_nop 1
    v_max_f32_dpp v54, v54, v54 row_mirror row_mask:0xf bank_mask:0xf
    v_mov_b32 v55, v54
    s_nop 1
    v_permlane16_swap_b32 v54, v55
    v_max_f32 v54, v54, v55
    v_mov_b32 v55, v54
    s_nop 1
    v_permlane32_swap_b32 v54, v55
    v_max_f32 v54, v54, v55
    v_mul_f32 v54, -v52, v54
    v_mov_b32 v55, 0
    v_pk_fma_f32 v[56:57], v[16:17], v[52:53], v[54:55]
    v_mul_f32 v65, 1132462080, v57
    v_fract_f32 v61, v57
    v_mul_f32 v64, 1132462080, v56
    v_fract_f32 v65, v65
    v_exp_f32 v60, v56
    v_cos_f32 v58, v61
    v_sin_f32 v59, v61
    v_exp_f32 v64, v64
    v_cos_f32 v62, v65
    v_sin_f32 v63, v65
    v_pk_mul_f32 v[58:59], v[58:59], v[60:61] op_sel:[0,0] op_sel_hi:[1,0]
    v_pk_mul_f32 v[62:63], v[62:63], v[64:65] op_sel:[0,0] op_sel_hi:[1,0]
    v_pk_mul_f32 v[68:69], v[58:59], v[58:59] op_sel:[0,0] op_sel_hi:[0,1]
    v_cvt_pk_f16_f32 v90, v58, -v59
    v_pk_mul_f32 v[76:77], v[62:63], v[62:63] op_sel:[0,0] op_sel_hi:[0,1]
    v_pk_fma_f32 v[66:67], v[58:59], v[58:59], v[68:69] op_sel:[1,1,0] op_sel_hi:[1,0,1] neg_lo:[1,0,0]
    v_cvt_pk_f16_f32 v93, v62, -v63
    v_pk_fma_f32 v[74:75], v[62:63], v[62:63], v[76:77] op_sel:[1,1,0] op_sel_hi:[1,0,1] neg_lo:[1,0,0]
    v_pk_mul_f32 v[72:73], v[66:67], v[66:67] op_sel:[0,0] op_sel_hi:[0,1]
    v_cvt_pk_f16_f32 v91, v66, -v67
    v_pk_mul_f32 v[80:81], v[74:75], v[74:75] op_sel:[0,0] op_sel_hi:[0,1]
    v_pk_fma_f32 v[70:71], v[66:67], v[66:67], v[72:73] op_sel:[1,1,0] op_sel_hi:[1,0,1] neg_lo:[1,0,0]
    v_cvt_pk_f16_f32 v94, v74, -v75
    v_pk_fma_f32 v[78:79], v[74:75], v[74:75], v[80:81] op_sel:[1,1,0] op_sel_hi:[1,0,1] neg_lo:[1,0,0]
    v_cvt_pk_f16_f32 v92, v70, -v71
    v_cvt_pk_f16_f32 v95, v78, -v79
    s_waitcnt lgkmcnt(0)
    s_nop 0
    v_pk_mul_f32 v[100:101], v[20:21], v[18:19] op_sel:[0,0] op_sel_hi:[0,1]
    v_pk_mul_f32 v[102:103], v[26:27], v[24:25] op_sel:[0,0] op_sel_hi:[0,1]
    v_pk_mul_f32 v[104:105], v[32:33], v[30:31] op_sel:[0,0] op_sel_hi:[0,1]
    v_pk_fma_f32 v[18:19], v[20:21], v[18:19], v[100:101] op_sel:[1,1,0] op_sel_hi:[1,0,1] neg_lo:[1,0,0]
    v_pk_fma_f32 v[24:25], v[26:27], v[24:25], v[102:103] op_sel:[1,1,0] op_sel_hi:[1,0,1] neg_lo:[1,0,0]
    v_pk_fma_f32 v[30:31], v[32:33], v[30:31], v[104:105] op_sel:[1,1,0] op_sel_hi:[1,0,1] neg_lo:[1,0,0]
    v_max3_f32 v100, abs(v18), abs(v19), abs(v24)
    v_max3_f32 v101, abs(v25), abs(v30), abs(v31)
    v_max_f32 v100, v100, v101
    s_nop 1
    v_max_f32_dpp v100, v100, v100 quad_perm:[1,0,3,2] row_mask:0xf bank_mask:0xf
    s_nop 1
    v_max_f32_dpp v100, v100, v100 quad_perm:[2,3,0,1] row_mask:0xf bank_mask:0xf
    s_nop 1
    v_max_f32_dpp v100, v100, v100 row_half_mirror row_mask:0xf bank_mask:0xf
    s_nop 1
    v_max_f32_dpp v100, v100, v100 row_mirror row_mask:0xf bank_mask:0xf
    v_mov_b32 v101, v100
    s_nop 1
    v_permlane16_swap_b32 v100, v101
    v_max_f32 v100, v100, v101
    v_mov_b32 v101, v100
    s_nop 1
    v_permlane32_swap_b32 v100, v101
    v_max_f32 v100, v100, v101
    v_frexp_exp_i32_f32 v100, v100
    v_sub_u32 v101, 14, v100
    v_subrev_u32 v100, 14, v100
    v_ldexp_f32 v100, v51, v100
    ds_write_b32 v235, v100
    v_ldexp_f32 v18, v18, v101
    v_ldexp_f32 v19, v19, v101
    v_cvt_pk_f16_f32 v20, v18, -v19
    v_ldexp_f32 v24, v24, v101
    v_ldexp_f32 v25, v25, v101
    v_cvt_pk_f16_f32 v26, v24, -v25
    v_ldexp_f32 v30, v30, v101
    v_ldexp_f32 v31, v31, v101
    v_cvt_pk_f16_f32 v32, v30, -v31
    v_pk_mul_f16 v100, v20, v94 op_sel:[0,0] op_sel_hi:[0,1]
    v_pk_mul_f16 v97, v20, v91 op_sel:[0,0] op_sel_hi:[0,1]
    v_pk_mul_f16 v98, v20, v92 op_sel:[0,0] op_sel_hi:[0,1]
    v_pk_mul_f16 v99, v20, v93 op_sel:[0,0] op_sel_hi:[0,1]
    v_pk_fma_f16 v140, v20, v94, v100 op_sel:[1,1,0] op_sel_hi:[1,0,1] neg_lo:[1,0,0]
    v_pk_mul_f16 v96, v20, v90 op_sel:[0,0] op_sel_hi:[0,1]
    v_pk_mul_f16 v101, v20, v95 op_sel:[0,0] op_sel_hi:[0,1]
    v_pk_fma_f16 v130, v20, v91, v97 op_sel:[1,1,0] op_sel_hi:[1,0,1] neg_lo:[1,0,0]
    v_pk_fma_f16 v132, v20, v92, v98 op_sel:[1,1,0] op_sel_hi:[1,0,1] neg_lo:[1,0,0]
    v_pk_fma_f16 v136, v20, v93, v99 op_sel:[1,1,0] op_sel_hi:[1,0,1] neg_lo:[1,0,0]
    s_bitcmp1_b32 s68, 0
    s_cbranch_scc1 L1_g_se_1
    global_load_dwordx2 v[42:43], v5, s[16:17] offset:0
    s_branch L1_g_se_1b
L1_g_se_1:
    s_nop 0
    global_load_dwordx2 v[34:35], v4, s[16:17] offset:0
L1_g_se_1b:
    v_pk_mul_f16 v99, v140, v93 op_sel:[0,0] op_sel_hi:[0,1]
    v_pk_fma_f16 v129, v20, v90, v96 op_sel:[1,1,0] op_sel_hi:[1,0,1] neg_lo:[1,0,0]
    v_pk_fma_f16 v144, v20, v95, v101 op_sel:[1,1,0] op_sel_hi:[1,0,1] neg_lo:[1,0,0]
    v_pk_mul_f16 v96, v130, v90 op_sel:[0,0] op_sel_hi:[0,1]
    v_pk_mul_f16 v97, v132, v90 op_sel:[0,0] op_sel_hi:[0,1]
    v_pk_fma_f16 v142, v140, v93, v99 op_sel:[1,1,0] op_sel_hi:[1,0,1] neg_lo:[1,0,0]
    v_pk_mul_f16 v98, v132, v91 op_sel:[0,0] op_sel_hi:[0,1]
    v_pk_mul_f16 v101, v144, v94 op_sel:[0,0] op_sel_hi:[0,1]
    v_pk_mul_f16 v99, v132, v94 op_sel:[0,0] op_sel_hi:[0,1]
    v_pk_fma_f16 v131, v130, v90, v96 op_sel:[1,1,0] op_sel_hi:[1,0,1] neg_lo:[1,0,0]
    v_pk_fma_f16 v133, v132, v90, v97 op_sel:[1,1,0] op_sel_hi:[1,0,1] neg_lo:[1,0,0]
    v_pk_mul_f16 v100, v144, v93 op_sel:[0,0] op_sel_hi:[0,1]
    v_pk_mul_f16 v96, v144, v95 op_sel:[0,0] op_sel_hi:[0,1]
    v_pk_mul_f16 v97, v130, v93 op_sel:[0,0] op_sel_hi:[0,1]
    v_pk_fma_f16 v134, v132, v91, v98 op_sel:[1,1,0] op_sel_hi:[1,0,1] neg_lo:[1,0,0]
    v_pk_fma_f16 v146, v144, v94, v101 op_sel:[1,1,0] op_sel_hi:[1,0,1] neg_lo:[1,0,0]
    v_pk_fma_f16 v141, v132, v94, v99 op_sel:[1,1,0] op_sel_hi:[1,0,1] neg_lo:[1,0,0]
    v_pk_fma_f16 v145, v144, v93, v100 op_sel:[1,1,0] op_sel_hi:[1,0,1] neg_lo:[1,0,0]
    v_pk_fma_f16 v148, v144, v95, v96 op_sel:[1,1,0] op_sel_hi:[1,0,1] neg_lo:[1,0,0]
    v_pk_fma_f16 v137, v130, v93, v97 op_sel:[1,1,0] op_sel_hi:[1,0,1] neg_lo:[1,0,0]
    v_pk_mul_f16 v98, v132, v93 op_sel:[0,0] op_sel_hi:[0,1]
    v_pk_mul_f16 v100, v134, v90 op_sel:[0,0] op_sel_hi:[0,1]
    v_pk_mul_f16 v101, v146, v93 op_sel:[0,0] op_sel_hi:[0,1]
    v_pk_mul_f16 v96, v134, v93 op_sel:[0,0] op_sel_hi:[0,1]
    v_pk_mul_f16 v97, v141, v93 op_sel:[0,0] op_sel_hi:[0,1]
    v_pk_fma_f16 v138, v132, v93, v98 op_sel:[1,1,0] op_sel_hi:[1,0,1] neg_lo:[1,0,0]
    v_pk_fma_f16 v135, v134, v90, v100 op_sel:[1,1,0] op_sel_hi:[1,0,1] neg_lo:[1,0,0]
    v_pk_fma_f16 v147, v146, v93, v101 op_sel:[1,1,0] op_sel_hi:[1,0,1] neg_lo:[1,0,0]
    v_pk_fma_f16 v139, v134, v93, v96 op_sel:[1,1,0] op_sel_hi:[1,0,1] neg_lo:[1,0,0]
    v_pk_fma_f16 v143, v141, v93, v97 op_sel:[1,1,0] op_sel_hi:[1,0,1] neg_lo:[1,0,0]
    s_bitcmp1_b32 s68, 0
    s_cbranch_scc1 L1_g_se_2
    global_load_dwordx2 v[44:45], v5, s[16:17] offset:1280
    s_branch L1_g_se_2b
L1_g_se_2:
    global_load_dwordx2 v[36:37], v4, s[16:17] offset:1280
L1_g_se_2b:
    ds_write_addtid_b32 v20 offset:0
    ds_write_addtid_b32 v129 offset:272
    ds_write_addtid_b32 v130 offset:544
    ds_write_addtid_b32 v132 offset:1088
    ds_write_addtid_b32 v136 offset:2176
    ds_write_addtid_b32 v140 offset:3264
    ds_write_addtid_b32 v144 offset:4352
    ds_write_addtid_b32 v131 offset:816
    ds_write_addtid_b32 v133 offset:1360
    ds_write_addtid_b32 v134 offset:1632
    ds_write_addtid_b32 v142 offset:3808
    ds_write_addtid_b32 v145 offset:4624
    ds_write_addtid_b32 v146 offset:4896
    ds_write_addtid_b32 v148 offset:5440
    ds_write_addtid_b32 v137 offset:2448
    ds_write_addtid_b32 v138 offset:2720
    ds_write_addtid_b32 v141 offset:3536
    ds_write_addtid_b32 v135 offset:1904
    ds_write_addtid_b32 v147 offset:5168
    ds_write_addtid_b32 v139 offset:2992
    ds_write_addtid_b32 v143 offset:4080
    s_add_u32 m0, m0, s60
    s_sub_u32 s60, 0, s60
    s_waitcnt lgkmcnt(0)
    s_barrier
    v_pk_fma_f32 v[56:57], v[22:23], v[52:53], v[54:55]
    ds_write_addtid_b32 v26 offset:0
    v_mul_f32 v65, 1132462080, v57
    v_fract_f32 v61, v57
    v_mul_f32 v64, 1132462080, v56
    v_fract_f32 v65, v65
    v_exp_f32 v60, v56
    v_cos_f32 v58, v61
    v_sin_f32 v59, v61
    v_exp_f32 v64, v64
    s_bitcmp1_b32 s68, 0
    s_cbranch_scc1 L1_g_se_3
    global_load_dwordx2 v[46:47], v5, s[16:17] offset:2560
    s_branch L1_g_se_3b
L1_g_se_3:
    global_load_dwordx2 v[38:39], v4, s[16:17] offset:2560
L1_g_se_3b:
    v_cos_f32 v62, v65
    v_sin_f32 v63, v65
    v_pk_mul_f32 v[58:59], v[58:59], v[60:61] op_sel:[0,0] op_sel_hi:[1,0]
    v_pk_mul_f32 v[62:63], v[62:63], v[64:65] op_sel:[0,0] op_sel_hi:[1,0]
    v_pk_mul_f32 v[68:69], v[58:59], v[58:59] op_sel:[0,0] op_sel_hi:[0,1]
    v_cvt_pk_f16_f32 v90, v58, -v59
    v_pk_mul_f32 v[76:77], v[62:63], v[62:63] op_sel:[0,0] op_sel_hi:[0,1]
    v_pk_fma_f32 v[66:67], v[58:59], v[58:59], v[68:69] op_sel:[1,1,0] op_sel_hi:[1,0,1] neg_lo:[1,0,0]
    v_cvt_pk_f16_f32 v93, v62, -v63
    v_pk_fma_f32 v[74:75], v[62:63], v[62:63], v[76:77] op_sel:[1,1,0] op_sel_hi:[1,0,1] neg_lo:[1,0,0]
    v_pk_mul_f32 v[72:73], v[66:67], v[66:67] op_sel:[0,0] op_sel_hi:[0,1]
    v_cvt_pk_f16_f32 v91, v66, -v67
    v_pk_mul_f32 v[80:81], v[74:75], v[74:75] op_sel:[0,0] op_sel_hi:[0,1]
    v_pk_fma_f32 v[70:71], v[66:67], v[66:67], v[72:73] op_sel:[1,1,0] op_sel_hi:[1,0,1] neg_lo:[1,0,0]
    v_cvt_pk_f16_f32 v94, v74, -v75
    v_pk_fma_f32 v[78:79], v[74:75], v[74:75], v[80:81] op_sel:[1,1,0] op_sel_hi:[1,0,1] neg_lo:[1,0,0]
    v_cvt_pk_f16_f32 v92, v70, -v71
    v_pk_mul_f16 v100, v26, v94 op_sel:[0,0] op_sel_hi:[0,1]
    v_cvt_pk_f16_f32 v95, v78, -v79
    v_pk_mul_f16 v97, v26, v91 op_sel:[0,0] op_sel_hi:[0,1]
    v_pk_mul_f16 v98, v26, v92 op_sel:[0,0] op_sel_hi:[0,1]
    v_pk_mul_f16 v99, v26, v93 op_sel:[0,0] op_sel_hi:[0,1]
    v_pk_fma_f16 v140, v26, v94, v100 op_sel:[1,1,0] op_sel_hi:[1,0,1] neg_lo:[1,0,0]
    v_pk_mul_f16 v96, v26, v90 op_sel:[0,0] op_sel_hi:[0,1]
    v_pk_mul_f16 v101, v26, v95 op_sel:[0,0] op_sel_hi:[0,1]
    v_pk_fma_f16 v130, v26, v91, v97 op_sel:[1,1,0] op_sel_hi:[1,0,1] neg_lo:[1,0,0]
    v_pk_fma_f16 v132, v26, v92, v98 op_sel:[1,1,0] op_sel_hi:[1,0,1] neg_lo:[1,0,0]
    v_pk_fma_f16 v136, v26, v93, v99 op_sel:[1,1,0] op_sel_hi:[1,0,1] neg_lo:[1,0,0]
    v_pk_mul_f16 v99, v140, v93 op_sel:[0,0] op_sel_hi:[0,1]
    v_pk_fma_f16 v129, v26, v90, v96 op_sel:[1,1,0] op_sel_hi:[1,0,1] neg_lo:[1,0,0]
    v_pk_fma_f16 v144, v26, v95, v101 op_sel:[1,1,0] op_sel_hi:[1,0,1] neg_lo:[1,0,0]
    v_pk_mul_f16 v96, v130, v90 op_sel:[0,0] op_sel_hi:[0,1]
    v_pk_mul_f16 v97, v132, v90 op_sel:[0,0] op_sel_hi:[0,1]
    v_pk_fma_f16 v142, v140, v93, v99 op_sel:[1,1,0] op_sel_hi:[1,0,1] neg_lo:[1,0,0]
    v_pk_mul_f16 v98, v132, v91 op_sel:[0,0] op_sel_hi:[0,1]
    v_pk_mul_f16 v101, v144, v94 op_sel:[0,0] op_sel_hi:[0,1]
    v_pk_mul_f16 v99, v132, v94 op_sel:[0,0] op_sel_hi:[0,1]
    v_pk_fma_f16 v131, v130, v90, v96 op_sel:[1,1,0] op_sel_hi:[1,0,1] neg_lo:[1,0,0]
    v_pk_fma_f16 v133, v132, v90, v97 op_sel:[1,1,0] op_sel_hi:[1,0,1] neg_lo:[1,0,0]
    v_pk_mul_f16 v100, v144, v93 op_sel:[0,0] op_sel_hi:[0,1]
    s_bitcmp1_b32 s68, 0
    s_cbranch_scc1 L1_g_se_4
    global_load_dwordx2 v[48:49], v5, s[16:17] offset:3840
    s_branch L1_g_se_4b
L1_g_se_4:
    s_nop 0
    global_load_dwordx2 v[40:41], v4, s[16:17] offset:3840
L1_g_se_4b:
    v_pk_mul_f16 v96, v144, v95 op_sel:[0,0] op_sel_hi:[0,1]
    v_pk_mul_f16 v97, v130, v93 op_sel:[0,0] op_sel_hi:[0,1]
    v_pk_fma_f16 v134, v132, v91, v98 op_sel:[1,1,0] op_sel_hi:[1,0,1] neg_lo:[1,0,0]
    v_pk_fma_f16 v146, v144, v94, v101 op_sel:[1,1,0] op_sel_hi:[1,0,1] neg_lo:[1,0,0]
    v_pk_fma_f16 v141, v132, v94, v99 op_sel:[1,1,0] op_sel_hi:[1,0,1] neg_lo:[1,0,0]
    v_pk_fma_f16 v145, v144, v93, v100 op_sel:[1,1,0] op_sel_hi:[1,0,1] neg_lo:[1,0,0]
    v_pk_fma_f16 v148, v144, v95, v96 op_sel:[1,1,0] op_sel_hi:[1,0,1] neg_lo:[1,0,0]
    v_pk_fma_f16 v137, v130, v93, v97 op_sel:[1,1,0] op_sel_hi:[1,0,1] neg_lo:[1,0,0]
    v_pk_mul_f16 v98, v132, v93 op_sel:[0,0] op_sel_hi:[0,1]
    v_pk_mul_f16 v100, v134, v90 op_sel:[0,0] op_sel_hi:[0,1]
    v_pk_mul_f16 v101, v146, v93 op_sel:[0,0] op_sel_hi:[0,1]
    v_pk_mul_f16 v96, v134, v93 op_sel:[0,0] op_sel_hi:[0,1]
    v_pk_mul_f16 v97, v141, v93 op_sel:[0,0] op_sel_hi:[0,1]
    v_pk_fma_f16 v138, v132, v93, v98 op_sel:[1,1,0] op_sel_hi:[1,0,1] neg_lo:[1,0,0]
    v_pk_fma_f16 v135, v134, v90, v100 op_sel:[1,1,0] op_sel_hi:[1,0,1] neg_lo:[1,0,0]
    v_pk_fma_f16 v147, v146, v93, v101 op_sel:[1,1,0] op_sel_hi:[1,0,1] neg_lo:[1,0,0]
    v_pk_fma_f16 v139, v134, v93, v96 op_sel:[1,1,0] op_sel_hi:[1,0,1] neg_lo:[1,0,0]
    v_pk_fma_f16 v143, v141, v93, v97 op_sel:[1,1,0] op_sel_hi:[1,0,1] neg_lo:[1,0,0]
    ds_write_addtid_b32 v129 offset:272
    ds_write_addtid_b32 v130 offset:544
    ds_write_addtid_b32 v132 offset:1088
    ds_write_addtid_b32 v136 offset:2176
    ds_write_addtid_b32 v140 offset:3264
    ds_write_addtid_b32 v144 offset:4352
    ds_write_addtid_b32 v131 offset:816
    ds_write_addtid_b32 v133 offset:1360
    ds_write_addtid_b32 v134 offset:1632
    ds_write_addtid_b32 v142 offset:3808
    ds_write_addtid_b32 v145 offset:4624
    ds_write_addtid_b32 v146 offset:4896
    ds_write_addtid_b32 v148 offset:5440
    ds_write_addtid_b32 v137 offset:2448
    ds_write_addtid_b32 v138 offset:2720
    ds_write_addtid_b32 v141 offset:3536
    ds_write_addtid_b32 v135 offset:1904
    ds_write_addtid_b32 v147 offset:5168
    ds_write_addtid_b32 v139 offset:2992
    ds_write_addtid_b32 v143 offset:4080
    s_add_u32 m0, m0, s60
    s_sub_u32 s60, 0, s60
    s_waitcnt lgkmcnt(0)
    s_barrier
    v_pk_fma_f32 v[56:57], v[28:29], v[52:53], v[54:55]
    ds_write_addtid_b32 v32 offset:0
    v_mul_f32 v65, 1132462080, v57
    v_fract_f32 v61, v57
    v_mul_f32 v64, 1132462080, v56
    v_fract_f32 v65, v65
    v_exp_f32 v60, v56
    v_cos_f32 v58, v61
    v_sin_f32 v59, v61
    v_exp_f32 v64, v64
    v_cos_f32 v62, v65
    v_sin_f32 v63, v65
    v_pk_mul_f32 v[58:59], v[58:59], v[60:61] op_sel:[0,0] op_sel_hi:[1,0]
    v_pk_mul_f32 v[62:63], v[62:63], v[64:65] op_sel:[0,0] op_sel_hi:[1,0]
    v_pk_mul_f32 v[68:69], v[58:59], v[58:59] op_sel:[0,0] op_sel_hi:[0,1]
    v_cvt_pk_f16_f32 v90, v58, -v59
    v_pk_mul_f32 v[76:77], v[62:63], v[62:63] op_sel:[0,0] op_sel_hi:[0,1]
    v_pk_fma_f32 v[66:67], v[58:59], v[58:59], v[68:69] op_sel:[1,1,0] op_sel_hi:[1,0,1] neg_lo:[1,0,0]
    v_cvt_pk_f16_f32 v93, v62, -v63
    v_pk_fma_f32 v[74:75], v[62:63], v[62:63], v[76:77] op_sel:[1,1,0] op_sel_hi:[1,0,1] neg_lo:[1,0,0]
    v_pk_mul_f32 v[72:73], v[66:67], v[66:67] op_sel:[0,0] op_sel_hi:[0,1]
    v_cvt_pk_f16_f32 v91, v66, -v67
    v_pk_mul_f32 v[80:81], v[74:75], v[74:75] op_sel:[0,0] op_sel_hi:[0,1]
    v_pk_fma_f32 v[70:71], v[66:67], v[66:67], v[72:73] op_sel:[1,1,0] op_sel_hi:[1,0,1] neg_lo:[1,0,0]
    v_cvt_pk_f16_f32 v94, v74, -v75
    v_pk_fma_f32 v[78:79], v[74:75], v[74:75], v[80:81] op_sel:[1,1,0] op_sel_hi:[1,0,1] neg_lo:[1,0,0]
    v_cvt_pk_f16_f32 v92, v70, -v71
    v_pk_mul_f16 v100, v32, v94 op_sel:[0,0] op_sel_hi:[0,1]
    v_cvt_pk_f16_f32 v95, v78, -v79
    v_pk_mul_f16 v97, v32, v91 op_sel:[0,0] op_sel_hi:[0,1]
    v_pk_mul_f16 v98, v32, v92 op_sel:[0,0] op_sel_hi:[0,1]
    v_pk_mul_f16 v99, v32, v93 op_sel:[0,0] op_sel_hi:[0,1]
    v_pk_fma_f16 v140, v32, v94, v100 op_sel:[1,1,0] op_sel_hi:[1,0,1] neg_lo:[1,0,0]
    v_pk_mul_f16 v96, v32, v90 op_sel:[0,0] op_sel_hi:[0,1]
    v_pk_mul_f16 v101, v32, v95 op_sel:[0,0] op_sel_hi:[0,1]
    v_pk_fma_f16 v130, v32, v91, v97 op_sel:[1,1,0] op_sel_hi:[1,0,1] neg_lo:[1,0,0]
    v_pk_fma_f16 v132, v32, v92, v98 op_sel:[1,1,0] op_sel_hi:[1,0,1] neg_lo:[1,0,0]
    v_pk_fma_f16 v136, v32, v93, v99 op_sel:[1,1,0] op_sel_hi:[1,0,1] neg_lo:[1,0,0]
    v_pk_mul_f16 v99, v140, v93 op_sel:[0,0] op_sel_hi:[0,1]
    v_pk_fma_f16 v129, v32, v90, v96 op_sel:[1,1,0] op_sel_hi:[1,0,1] neg_lo:[1,0,0]
    v_pk_fma_f16 v144, v32, v95, v101 op_sel:[1,1,0] op_sel_hi:[1,0,1] neg_lo:[1,0,0]
    v_pk_mul_f16 v96, v130, v90 op_sel:[0,0] op_sel_hi:[0,1]
    v_pk_mul_f16 v97, v132, v90 op_sel:[0,0] op_sel_hi:[0,1]
    v_pk_fma_f16 v142, v140, v93, v99 op_sel:[1,1,0] op_sel_hi:[1,0,1] neg_lo:[1,0,0]
    v_pk_mul_f16 v98, v132, v91 op_sel:[0,0] op_sel_hi:[0,1]
    v_pk_mul_f16 v101, v144, v94 op_sel:[0,0] op_sel_hi:[0,1]
    v_pk_mul_f16 v99, v132, v94 op_sel:[0,0] op_sel_hi:[0,1]
    v_pk_fma_f16 v131, v130, v90, v96 op_sel:[1,1,0] op_sel_hi:[1,0,1] neg_lo:[1,0,0]
    v_pk_fma_f16 v133, v132, v90, v97 op_sel:[1,1,0] op_sel_hi:[1,0,1] neg_lo:[1,0,0]
    v_pk_mul_f16 v100, v144, v93 op_sel:[0,0] op_sel_hi:[0,1]
    v_pk_mul_f16 v96, v144, v95 op_sel:[0,0] op_sel_hi:[0,1]
    v_pk_mul_f16 v97, v130, v93 op_sel:[0,0] op_sel_hi:[0,1]
    v_pk_fma_f16 v134, v132, v91, v98 op_sel:[1,1,0] op_sel_hi:[1,0,1] neg_lo:[1,0,0]
    v_pk_fma_f16 v146, v144, v94, v101 op_sel:[1,1,0] op_sel_hi:[1,0,1] neg_lo:[1,0,0]
    v_pk_fma_f16 v141, v132, v94, v99 op_sel:[1,1,0] op_sel_hi:[1,0,1] neg_lo:[1,0,0]
    v_pk_fma_f16 v145, v144, v93, v100 op_sel:[1,1,0] op_sel_hi:[1,0,1] neg_lo:[1,0,0]
    v_pk_fma_f16 v148, v144, v95, v96 op_sel:[1,1,0] op_sel_hi:[1,0,1] neg_lo:[1,0,0]
    v_pk_fma_f16 v137, v130, v93, v97 op_sel:[1,1,0] op_sel_hi:[1,0,1] neg_lo:[1,0,0]
    v_pk_mul_f16 v98, v132, v93 op_sel:[0,0] op_sel_hi:[0,1]
    v_pk_mul_f16 v100, v134, v90 op_sel:[0,0] op_sel_hi:[0,1]
    v_pk_mul_f16 v101, v146, v93 op_sel:[0,0] op_sel_hi:[0,1]
    v_pk_mul_f16 v96, v134, v93 op_sel:[0,0] op_sel_hi:[0,1]
    v_pk_mul_f16 v97, v141, v93 op_sel:[0,0] op_sel_hi:[0,1]
    v_pk_fma_f16 v138, v132, v93, v98 op_sel:[1,1,0] op_sel_hi:[1,0,1] neg_lo:[1,0,0]
    v_pk_fma_f16 v135, v134, v90, v100 op_sel:[1,1,0] op_sel_hi:[1,0,1] neg_lo:[1,0,0]
    v_pk_fma_f16 v147, v146, v93, v101 op_sel:[1,1,0] op_sel_hi:[1,0,1] neg_lo:[1,0,0]
    v_pk_fma_f16 v139, v134, v93, v96 op_sel:[1,1,0] op_sel_hi:[1,0,1] neg_lo:[1,0,0]
    v_pk_fma_f16 v143, v141, v93, v97 op_sel:[1,1,0] op_sel_hi:[1,0,1] neg_lo:[1,0,0]
    ds_write_addtid_b32 v129 offset:272
    ds_write_addtid_b32 v130 offset:544
    ds_write_addtid_b32 v132 offset:1088
    ds_write_addtid_b32 v136 offset:2176
    ds_write_addtid_b32 v140 offset:3264
    ds_write_addtid_b32 v144 offset:4352
    ds_write_addtid_b32 v131 offset:816
    ds_write_addtid_b32 v133 offset:1360
    ds_write_addtid_b32 v134 offset:1632
    ds_write_addtid_b32 v142 offset:3808
    ds_write_addtid_b32 v145 offset:4624
    ds_write_addtid_b32 v146 offset:4896
    ds_write_addtid_b32 v148 offset:5440
    ds_write_addtid_b32 v137 offset:2448
    ds_write_addtid_b32 v138 offset:2720
    ds_write_addtid_b32 v141 offset:3536
    ds_write_addtid_b32 v135 offset:1904
    ds_write_addtid_b32 v147 offset:5168
    ds_write_addtid_b32 v139 offset:2992
    ds_write_addtid_b32 v143 offset:4080
    global_load_dwordx4 v[104:107], v231, s[42:43] offset:0 sc1
    global_load_dwordx4 v[108:111], v231, s[42:43] offset:16 sc1
    global_load_dwordx4 v[112:115], v231, s[42:43] offset:32 sc1
    global_load_dwordx4 v[116:119], v231, s[42:43] offset:48 sc1
    global_load_dword v120, v234, s[40:41] sc1
    s_waitcnt lgkmcnt(0)
    s_barrier
    s_setprio 0
    s_waitcnt vmcnt(5)
    v_perm_b32 v160, v36, v34, s52
    v_perm_b32 v161, v40, v38, s52
    v_perm_b32 v162, v44, v42, s52
    v_perm_b32 v163, v48, v46, s52
    ds_write_b128 v233, v[160:163] offset:0
    v_perm_b32 v164, v36, v34, s53
    v_perm_b32 v165, v40, v38, s53
    v_perm_b32 v166, v44, v42, s53
    v_perm_b32 v167, v48, v46, s53
    ds_write_b128 v233, v[164:167] offset:4096
    v_perm_b32 v168, v37, v35, s52
    v_perm_b32 v169, v41, v39, s52
    v_perm_b32 v170, v45, v43, s52
    v_perm_b32 v171, v49, v47, s52
    ds_write_b128 v233, v[168:171] offset:8192
    v_perm_b32 v172, v37, v35, s53
    v_perm_b32 v173, v41, v39, s53
    v_perm_b32 v174, v45, v43, s53
    v_perm_b32 v175, v49, v47, s53
    ds_write_b128 v233, v[172:175] offset:12288
    v_lshlrev_b32 v192, 16, v34
    v_lshlrev_b32 v193, 16, v36
    v_lshlrev_b32 v194, 16, v38
    v_lshlrev_b32 v195, 16, v40
    v_lshlrev_b32 v196, 16, v42
    v_lshlrev_b32 v197, 16, v44
    v_lshlrev_b32 v198, 16, v46
    v_lshlrev_b32 v199, 16, v48
    v_and_b32 v200, 0xffff0000, v34
    v_and_b32 v201, 0xffff0000, v36
    v_and_b32 v202, 0xffff0000, v38
    v_and_b32 v203, 0xffff0000, v40
    v_and_b32 v204, 0xffff0000, v42
    v_and_b32 v205, 0xffff0000, v44
    v_and_b32 v206, 0xffff0000, v46
    v_and_b32 v207, 0xffff0000, v48
    v_lshlrev_b32 v208, 16, v35
    v_lshlrev_b32 v209, 16, v37
    v_lshlrev_b32 v210, 16, v39
    v_lshlrev_b32 v211, 16, v41
    v_lshlrev_b32 v212, 16, v43
    v_lshlrev_b32 v213, 16, v45
    v_lshlrev_b32 v214, 16, v47
    v_lshlrev_b32 v215, 16, v49
    v_and_b32 v216, 0xffff0000, v35
    v_and_b32 v217, 0xffff0000, v37
    v_and_b32 v218, 0xffff0000, v39
    v_and_b32 v219, 0xffff0000, v41
    v_and_b32 v220, 0xffff0000, v43
    v_and_b32 v221, 0xffff0000, v45
    v_and_b32 v222, 0xffff0000, v47
    v_and_b32 v223, 0xffff0000, v49
L1_poll:
    s_waitcnt vmcnt(0)
    v_cmp_ne_u32 vcc, v107, v120
    v_cmp_ne_u32 s[60:61], v111, v120
    v_cmp_ne_u32 s[62:63], v115, v120
    v_cmp_ne_u32 s[64:65], v119, v120
    v_cmp_eq_u32 s[66:67], 0, v120
    s_or_b64 vcc, vcc, s[60:61]
    s_or_b64 s[62:63], s[62:63], s[64:65]
    s_or_b64 vcc, vcc, s[66:67]
    s_or_b64 vcc, vcc, s[62:63]
    s_cbranch_scc0 L1_go
    s_sleep 1
    global_load_dwordx4 v[104:107], v231, s[42:43] offset:0 sc1
    global_load_dwordx4 v[108:111], v231, s[42:43] offset:16 sc1
    global_load_dwordx4 v[112:115], v231, s[42:43] offset:32 sc1
    global_load_dwordx4 v[116:119], v231, s[42:43] offset:48 sc1
    global_load_dword v120, v234, s[40:41] sc1
    s_branch L1_poll
L1_go:
    v_lshlrev_b32 v82, 16, v106
    v_and_b32 v83, 0xffff0000, v106
    v_pk_mul_f32 v[82:83], v[82:83], v[104:105] neg_lo:[1,0] neg_hi:[1,0]
    v_lshlrev_b32 v84, 16, v110
    v_and_b32 v85, 0xffff0000, v110
    v_pk_mul_f32 v[84:85], v[84:85], v[108:109] neg_lo:[1,0] neg_hi:[1,0]
    v_lshlrev_b32 v86, 16, v114
    v_and_b32 v87, 0xffff0000, v114
    v_pk_mul_f32 v[86:87], v[86:87], v[112:113] neg_lo:[1,0] neg_hi:[1,0]
    v_lshlrev_b32_e64 v88, 16, v118
    v_and_b32 v89, 0xffff0000, v118
    v_pk_mul_f32 v[88:89], v[88:89], v[116:117] neg_lo:[1,0] neg_hi:[1,0]
    v_pk_fma_f32 v[128:129], v[192:193], v[104:105], v[82:83]
    v_pk_fma_f32 v[130:131], v[194:195], v[108:109], v[84:85]
    v_pk_fma_f32 v[132:133], v[196:197], v[112:113], v[86:87]
    v_pk_fma_f32 v[134:135], v[198:199], v[116:117], v[88:89]
    v_cvt_pk_bf16_f32 v160, v135, v134
    v_cvt_pk_bf16_f32 v161, v133, v132
    v_cvt_pk_bf16_f32 v162, v131, v130
    v_cvt_pk_bf16_f32 v163, v129, v128
    ds_write_b128 v232, v[160:163] offset:0
    v_pk_fma_f32 v[136:137], v[200:201], v[104:105], v[82:83]
    v_pk_fma_f32 v[138:139], v[202:203], v[108:109], v[84:85]
    v_pk_fma_f32 v[140:141], v[204:205], v[112:113], v[86:87]
    v_pk_fma_f32 v[142:143], v[206:207], v[116:117], v[88:89]
    v_cvt_pk_bf16_f32 v164, v143, v142
    v_cvt_pk_bf16_f32 v165, v141, v140
    v_cvt_pk_bf16_f32 v166, v139, v138
    v_cvt_pk_bf16_f32 v167, v137, v136
    ds_write_b128 v232, v[164:167] offset:4608
    v_pk_fma_f32 v[144:145], v[208:209], v[104:105], v[82:83]
    v_pk_fma_f32 v[146:147], v[210:211], v[108:109], v[84:85]
    v_pk_fma_f32 v[148:149], v[212:213], v[112:113], v[86:87]
    v_pk_fma_f32 v[150:151], v[214:215], v[116:117], v[88:89]
    v_cvt_pk_bf16_f32 v168, v151, v150
    v_cvt_pk_bf16_f32 v169, v149, v148
    v_cvt_pk_bf16_f32 v170, v147, v146
    v_cvt_pk_bf16_f32 v171, v145, v144
    ds_write_b128 v232, v[168:171] offset:9216
    v_pk_fma_f32 v[152:153], v[216:217], v[104:105], v[82:83]
    v_pk_fma_f32 v[154:155], v[218:219], v[108:109], v[84:85]
    v_pk_fma_f32 v[156:157], v[220:221], v[112:113], v[86:87]
    v_pk_fma_f32 v[158:159], v[222:223], v[116:117], v[88:89]
    v_cvt_pk_bf16_f32 v172, v159, v158
    v_cvt_pk_bf16_f32 v173, v157, v156
    v_cvt_pk_bf16_f32 v174, v155, v154
    v_cvt_pk_bf16_f32 v175, v153, v152
    ds_write_b128 v232, v[172:175] offset:13824
    s_waitcnt lgkmcnt(0)
    s_barrier
    s_branch LF_G
L1_grow:
    v_and_b32 v128, 31, v1
    v_lshlrev_b32 v128, 3, v128
    v_cmp_gt_u32 vcc, 32, v1
    v_mov_b32 v129, 4
    v_mov_b32 v130, 0
    v_cndmask_b32 v129, v129, v130, vcc
    v_add_u32 v129, v129, v128
    v_cvt_f32_u32 v129, v129
    v_mul_f32 v129, -v54, v129
    v_exp_f32 v129, v129
    s_nop 0
    v_mul_f32 v112, v112, v129
    v_mov_b32 v129, 5
    v_mov_b32 v130, 1
    v_cndmask_b32 v129, v129, v130, vcc
    v_add_u32 v129, v129, v128
    v_cvt_f32_u32 v129, v129
    v_mul_f32 v129, -v54, v129
    v_exp_f32 v129, v129
    s_nop 0
    v_mul_f32 v113, v113, v129
    v_mov_b32 v129, 6
    v_mov_b32 v130, 2
    v_cndmask_b32 v129, v129, v130, vcc
    v_add_u32 v129, v129, v128
    v_cvt_f32_u32 v129, v129
    v_mul_f32 v129, -v54, v129
    v_exp_f32 v129, v129
    s_nop 0
    v_mul_f32 v114, v114, v129
    v_mov_b32 v129, 7
    v_mov_b32 v130, 3
    v_cndmask_b32 v129, v129, v130, vcc
    v_add_u32 v129, v129, v128
    v_cvt_f32_u32 v129, v129
    v_mul_f32 v129, -v54, v129
    v_exp_f32 v129, v129
    s_nop 0
    v_mul_f32 v115, v115, v129
    v_mov_b32 v129, 512
    v_mov_b32 v130, 256
    v_cndmask_b32 v129, v129, v130, vcc
    v_add_u32 v129, v129, v128
    v_cvt_f32_u32 v129, v129
    v_mul_f32 v129, -v54, v129
    v_exp_f32 v129, v129
    s_nop 0
    v_mul_f32 v116, v116, v129
    v_mov_b32 v129, 516
    v_mov_b32 v130, 258
    v_cndmask_b32 v129, v129, v130, vcc
    v_add_u32 v129, v129, v128
    v_cvt_f32_u32 v129, v129
    v_mul_f32 v129, -v54, v129
    v_exp_f32 v129, v129
    s_nop 0
    v_mul_f32 v117, v117, v129
    v_mov_b32 v129, 768
    v_mov_b32 v130, 260
    v_cndmask_b32 v129, v129, v130, vcc
    v_add_u32 v129, v129, v128
    v_cvt_f32_u32 v129, v129
    v_mul_f32 v129, -v54, v129
    v_exp_f32 v129, v129
    s_nop 0
    v_mul_f32 v118, v118, v129
    v_mov_b32 v129, 772
    v_mov_b32 v130, 262
    v_cndmask_b32 v129, v129, v130, vcc
    v_add_u32 v129, v129, v128
    v_cvt_f32_u32 v129, v129
    v_mul_f32 v129, -v54, v129
    v_exp_f32 v129, v129
    s_nop 0
    v_mul_f32 v119, v119, v129
    v_mov_b32 v129, 2048
    v_mov_b32 v130, 1024
    v_cndmask_b32 v129, v129, v130, vcc
    v_add_u32 v129, v129, v128
    v_cvt_f32_u32 v129, v129
    v_mul_f32 v129, -v54, v129
    v_exp_f32 v129, v129
    s_nop 0
    v_mul_f32 v120, v120, v129
    v_mov_b32 v129, 2048
    v_mov_b32 v130, 1280
    v_cndmask_b32 v129, v129, v130, vcc
    v_add_u32 v129, v129, v128
    v_cvt_f32_u32 v129, v129
    v_mul_f32 v129, -v54, v129
    v_exp_f32 v129, v129
    s_nop 0
    v_mul_f32 v121, v121, v129
    v_mov_b32 v129, 2048
    v_mov_b32 v130, 1536
    v_cndmask_b32 v129, v129, v130, vcc
    v_add_u32 v129, v129, v128
    v_cvt_f32_u32 v129, v129
    v_mul_f32 v129, -v54, v129
    v_exp_f32 v129, v129
    s_nop 0
    v_mul_f32 v122, v122, v129
    v_mov_b32 v129, 2048
    v_mov_b32 v130, 1792
    v_cndmask_b32 v129, v129, v130, vcc
    v_add_u32 v129, v129, v128
    v_cvt_f32_u32 v129, v129
    v_mul_f32 v129, -v54, v129
    v_exp_f32 v129, v129
    s_nop 0
    v_mul_f32 v123, v123, v129
    s_branch L1_grown
L1_sp0:
    s_sub_u32 s4, s2, 160
    s_mul_i32 s10, s4, 7
    s_add_u32 s10, s10, s3
    s_mul_i32 s11, s10, 5120
    s_mul_i32 s12, s3, 5120
    s_add_u32 m0, s12, 4096
    v_lshl_add_u32 v4, v1, 4, s11
    s_cmp_eq_u32 s3, 7
    s_cselect_b32 s10, 512, s10
    s_cmp_ge_u32 s10, 512
    s_waitcnt lgkmcnt(0)
    s_cbranch_scc1 L1_spare
    global_load_lds_dwordx4 v4, s[16:17]
    global_load_lds_dwordx4 v4, s[16:17] offset:1024
    global_load_lds_dwordx4 v4, s[16:17] offset:2048
    global_load_lds_dwordx4 v4, s[16:17] offset:3072
    s_add_u32 m0, m0, 4096
    v_add_u32 v4, 4096, v4
    global_load_lds_dwordx4 v4, s[16:17]
L1_spare:
    v_mov_b32 v6, 0
    s_mov_b32 s52, 0x3f803f80
    s_cmp_eq_u32 s3, 7
    s_cbranch_scc1 L1_pollw
    s_cmp_ge_u32 s10, 512
    s_cbranch_scc1 L1_bar
    v_lshrrev_b32 v4, 5, v1
    v_mul_u32_u24 v4, 1280, v4
    v_and_b32 v5, 31, v1
    v_lshl_add_u32 v4, v5, 3, v4
    v_add_u32 v4, s12, v4
    v_mov_b32 v160, 0
    v_mov_b32 v161, 0
    v_mov_b32 v162, 0
    v_mov_b32 v163, 0
    v_and_b32 v8, 1, v1
    v_cmp_eq_u32 vcc, 1, v8
    v_lshlrev_b32 v9, 4, v1
    s_lshl_b32 s11, s3, 5
    v_add_u32 v9, s11, v9
    s_waitcnt vmcnt(0)
    ds_read_b64 v[16:17], v4 offset:4096
    ds_read_b64 v[26:27], v4 offset:6656
    ds_read_b64 v[18:19], v4 offset:4352
    ds_read_b64 v[28:29], v4 offset:6912
    ds_read_b64 v[20:21], v4 offset:4608
    ds_read_b64 v[30:31], v4 offset:7168
    ds_read_b64 v[22:23], v4 offset:4864
    ds_read_b64 v[32:33], v4 offset:7424
    ds_read_b64 v[24:25], v4 offset:5120
    ds_read_b64 v[34:35], v4 offset:7680
    s_waitcnt lgkmcnt(8)
    v_dot2_f32_bf16 v160, v16, s52, v160
    v_dot2_f32_bf16 v162, v16, v16, v162
    v_dot2_f32_bf16 v161, v26, s52, v161
    v_dot2_f32_bf16 v163, v26, v26, v163
    v_dot2_f32_bf16 v160, v17, s52, v160
    v_dot2_f32_bf16 v162, v17, v17, v162
    v_dot2_f32_bf16 v161, v27, s52, v161
    v_dot2_f32_bf16 v163, v27, v27, v163
    s_waitcnt lgkmcnt(6)
    s_nop 0
    v_dot2_f32_bf16 v160, v18, s52, v160
    v_dot2_f32_bf16 v162, v18, v18, v162
    v_dot2_f32_bf16 v161, v28, s52, v161
    v_dot2_f32_bf16 v163, v28, v28, v163
    v_dot2_f32_bf16 v160, v19, s52, v160
    v_dot2_f32_bf16 v162, v19, v19, v162
    v_dot2_f32_bf16 v161, v29, s52, v161
    v_dot2_f32_bf16 v163, v29, v29, v163
    s_waitcnt lgkmcnt(4)
    s_nop 0
    v_dot2_f32_bf16 v160, v20, s52, v160
    v_dot2_f32_bf16 v162, v20, v20, v162
    v_dot2_f32_bf16 v161, v30, s52, v161
    v_dot2_f32_bf16 v163, v30, v30, v163
    v_dot2_f32_bf16 v160, v21, s52, v160
    v_dot2_f32_bf16 v162, v21, v21, v162
    v_dot2_f32_bf16 v161, v31, s52, v161
    v_dot2_f32_bf16 v163, v31, v31, v163
    s_waitcnt lgkmcnt(2)
    s_nop 0
    v_dot2_f32_bf16 v160, v22, s52, v160
    v_dot2_f32_bf16 v162, v22, v22, v162
    v_dot2_f32_bf16 v161, v32, s52, v161
    v_dot2_f32_bf16 v163, v32, v32, v163
    v_dot2_f32_bf16 v160, v23, s52, v160
    v_dot2_f32_bf16 v162, v23, v23, v162
    v_dot2_f32_bf16 v161, v33, s52, v161
    v_dot2_f32_bf16 v163, v33, v33, v163
    s_waitcnt lgkmcnt(0)
    s_nop 0
    v_dot2_f32_bf16 v160, v24, s52, v160
    v_dot2_f32_bf16 v162, v24, v24, v162
    v_dot2_f32_bf16 v161, v34, s52, v161
    v_dot2_f32_bf16 v163, v34, v34, v163
    v_dot2_f32_bf16 v160, v25, s52, v160
    v_dot2_f32_bf16 v162, v25, v25, v162
    v_dot2_f32_bf16 v161, v35, s52, v161
    v_dot2_f32_bf16 v163, v35, v35, v163
    v_add_f32_dpp v160, v160, v160 quad_perm:[1,0,3,2] row_mask:0xf bank_mask:0xf
    s_nop 0
    s_nop 0
    v_add_f32_dpp v161, v161, v161 quad_perm:[1,0,3,2] row_mask:0xf bank_mask:0xf
    v_add_f32_dpp v162, v162, v162 quad_perm:[1,0,3,2] row_mask:0xf bank_mask:0xf
    v_add_f32_dpp v163, v163, v163 quad_perm:[1,0,3,2] row_mask:0xf bank_mask:0xf
    v_add_f32_dpp v160, v160, v160 quad_perm:[2,3,0,1] row_mask:0xf bank_mask:0xf
    v_add_f32_dpp v161, v161, v161 quad_perm:[2,3,0,1] row_mask:0xf bank_mask:0xf
    v_add_f32_dpp v162, v162, v162 quad_perm:[2,3,0,1] row_mask:0xf bank_mask:0xf
    v_add_f32_dpp v163, v163, v163 quad_perm:[2,3,0,1] row_mask:0xf bank_mask:0xf
    v_add_f32_dpp v160, v160, v160 row_half_mirror row_mask:0xf bank_mask:0xf
    v_add_f32_dpp v161, v161, v161 row_half_mirror row_mask:0xf bank_mask:0xf
    v_add_f32_dpp v162, v162, v162 row_half_mirror row_mask:0xf bank_mask:0xf
    v_add_f32_dpp v163, v163, v163 row_half_mirror row_mask:0xf bank_mask:0xf
    v_add_f32_dpp v160, v160, v160 row_mirror row_mask:0xf bank_mask:0xf
    v_add_f32_dpp v161, v161, v161 row_mirror row_mask:0xf bank_mask:0xf
    v_add_f32_dpp v162, v162, v162 row_mirror row_mask:0xf bank_mask:0xf
    v_add_f32_dpp v163, v163, v163 row_mirror row_mask:0xf bank_mask:0xf
    v_mov_b32 v168, v160
    v_mov_b32 v169, v161
    v_mov_b32 v170, v162
    v_mov_b32 v171, v163
    v_permlane16_swap_b32 v160, v168
    v_permlane16_swap_b32 v161, v169
    v_permlane16_swap_b32 v162, v170
    v_permlane16_swap_b32 v163, v171
    v_add_f32 v160, v160, v168
    v_add_f32 v161, v161, v169
    v_add_f32 v162, v162, v170
    v_add_f32 v163, v163, v171
    v_cndmask_b32 v160, v160, v161, vcc
    v_cndmask_b32 v164, v162, v163, vcc
    v_mul_f32 v160, 986500301, v160
    v_mul_f32 v164, 986500301, v164
    v_fma_f32 v164, -v160, v160, v164
    v_max_f32 v164, 0, v164
    v_cvt_pk_bf16_f32 v168, v160, v164
    v_lshlrev_b32 v170, 16, v168
    v_and_b32 v168, 0xffff0000, v168
    v_add_f32 v168, 925353388, v168
    v_cvt_pk_bf16_f32 v168, v168, v168
    v_and_b32 v168, 0xffff0000, v168
    v_sqrt_f32 v168, v168
    s_nop 0
    v_cvt_pk_bf16_f32 v168, v168, v168
    v_and_b32 v171, 0xffff0000, v168
    v_rcp_f32 v172, v171
    v_mov_b32 v176, v170
    v_mov_b32 v173, v172
    s_nop 0
    v_permlane32_swap_b32 v170, v176
    v_permlane32_swap_b32 v172, v173
    v_lshrrev_b32 v170, 16, v170
    v_or_b32 v174, v170, v176
    s_mov_b64 exec, 3
    ds_write_b128 v9, v[172:175]
    s_mov_b64 exec, -1
    s_branch L1_bar
L1_pollw:
    global_load_dword v8, v6, s[42:43]
    s_mul_i32 s11, s4, 14
    v_add_u32 v9, s11, v1
    v_cmp_gt_u32 s[60:61], 14, v1
    v_cmp_gt_u32 vcc, 0x400, v9
    s_nop 0
    s_and_b64 s[60:61], s[60:61], vcc
    v_lshlrev_b32 v9, 4, v9
    v_lshlrev_b32 v10, 4, v1
L1_pollw2:
    global_load_dword v7, v6, s[40:41] sc1
    s_waitcnt vmcnt(0)
    v_cmp_eq_u32 vcc, 0, v7
    s_cbranch_vccnz L1_pollw2
L1_pollw3:
    s_barrier
    ds_read_b128 v[172:175], v10
    s_mov_b64 exec, s[60:61]
    s_waitcnt lgkmcnt(0)
    s_cbranch_execz L1_pub
    v_mov_b32 v175, v7
    global_store_dwordx4 v9, v[172:175], s[42:43] sc1
L1_pub:
    s_mov_b64 exec, -1
    s_branch L1_cs
L1_bar:
    s_waitcnt lgkmcnt(0)
    s_barrier
L1_cs0:
    s_branch L1_cs
L1_cs:
    s_load_dwordx4 s[36:39], s[0:1], 80
    s_load_dwordx2 s[56:57], s[0:1], 96
    s_mov_b32 s58, 1966080
    s_mov_b32 s59, 0x20000
    v_and_b32 v208, 15, v1
    s_cmp_lt_u32 s3, 4
    s_waitcnt lgkmcnt(0)
    s_cbranch_scc1 L1_w2
    s_and_b32 s5, s2, 7
    s_lshr_b32 s6, s4, 3
    s_cmp_ge_u32 s6, 6
    s_cselect_b32 s7, 1, 0
    s_cselect_b32 s56, s38, s36
    s_cselect_b32 s57, s39, s37
    s_mul_i32 s8, s7, 6
    s_sub_u32 s8, s6, s8
    s_and_b32 s9, s5, 3
    s_mul_i32 s9, s9, 384
    s_lshl_b32 s8, s8, 6
    s_add_u32 s8, s8, s9
    v_bfe_u32 v2, v0, 3, 5
    v_mul_u32_u24 v2, 3072, v2
    v_and_b32 v3, 7, v0
    v_lshl_add_u32 v2, v3, 4, v2
    s_lshl_b32 s9, s8, 1
    v_add_u32 v2, s9, v2
    s_mov_b32 s53, 0x00003f80
    s_mov_b32 s54, 0x3f800000
    s_mov_b32 s12, 0
    buffer_load_dwordx4 v[64:67], v2, s[56:59], s12 offen
    s_add_u32 s12, s12, 98304
    buffer_load_dwordx4 v[68:71], v2, s[56:59], s12 offen
    s_add_u32 s12, s12, 98304
    buffer_load_dwordx4 v[72:75], v2, s[56:59], s12 offen
    s_add_u32 s12, s12, 98304
    buffer_load_dwordx4 v[76:79], v2, s[56:59], s12 offen
    s_add_u32 s12, s12, 98304
    buffer_load_dwordx4 v[80:83], v2, s[56:59], s12 offen
    s_add_u32 s12, s12, 98304
    buffer_load_dwordx4 v[84:87], v2, s[56:59], s12 offen
    s_add_u32 s12, s12, 98304
    buffer_load_dwordx4 v[88:91], v2, s[56:59], s12 offen
    s_add_u32 s12, s12, 98304
    buffer_load_dwordx4 v[92:95], v2, s[56:59], s12 offen
    s_add_u32 s12, s12, 98304
    buffer_load_dwordx4 v[96:99], v2, s[56:59], s12 offen
    s_add_u32 s12, s12, 98304
    buffer_load_dwordx4 v[100:103], v2, s[56:59], s12 offen
    s_add_u32 s12, s12, 98304
    buffer_load_dwordx4 v[104:107], v2, s[56:59], s12 offen
    s_add_u32 s12, s12, 98304
    buffer_load_dwordx4 v[108:111], v2, s[56:59], s12 offen
    s_add_u32 s12, s12, 98304
    buffer_load_dwordx4 v[112:115], v2, s[56:59], s12 offen
    s_add_u32 s12, s12, 98304
    buffer_load_dwordx4 v[116:119], v2, s[56:59], s12 offen
    s_add_u32 s12, s12, 98304
    buffer_load_dwordx4 v[120:123], v2, s[56:59], s12 offen
    s_add_u32 s12, s12, 98304
    buffer_load_dwordx4 v[124:127], v2, s[56:59], s12 offen
    s_add_u32 s12, s12, 98304
    buffer_load_dwordx4 v[128:131], v2, s[56:59], s12 offen
    s_add_u32 s12, s12, 98304
    buffer_load_dwordx4 v[132:135], v2, s[56:59], s12 offen
    s_add_u32 s12, s12, 98304
    buffer_load_dwordx4 v[136:139], v2, s[56:59], s12 offen
    s_add_u32 s12, s12, 98304
    buffer_load_dwordx4 v[140:143], v2, s[56:59], s12 offen
    s_add_u32 s12, s12, 98304
    v_mov_b64 v[16:17], 0
    v_mov_b64 v[18:19], 0
    v_mov_b64 v[20:21], 0
    v_mov_b64 v[22:23], 0
    s_mov_b32 s12, 0
L1_csl:
    s_waitcnt vmcnt(0)
    v_dot2_f32_bf16 v16, v64, s53, v16
    v_dot2_f32_bf16 v17, v64, s54, v17
    v_dot2_f32_bf16 v18, v65, s53, v18
    v_dot2_f32_bf16 v19, v65, s54, v19
    v_dot2_f32_bf16 v20, v66, s53, v20
    v_dot2_f32_bf16 v21, v66, s54, v21
    v_dot2_f32_bf16 v22, v67, s53, v22
    v_dot2_f32_bf16 v23, v67, s54, v23
    v_dot2_f32_bf16 v16, v68, s53, v16
    v_dot2_f32_bf16 v17, v68, s54, v17
    v_dot2_f32_bf16 v18, v69, s53, v18
    v_dot2_f32_bf16 v19, v69, s54, v19
    v_dot2_f32_bf16 v20, v70, s53, v20
    v_dot2_f32_bf16 v21, v70, s54, v21
    v_dot2_f32_bf16 v22, v71, s53, v22
    v_dot2_f32_bf16 v23, v71, s54, v23
    v_dot2_f32_bf16 v16, v72, s53, v16
    v_dot2_f32_bf16 v17, v72, s54, v17
    v_dot2_f32_bf16 v18, v73, s53, v18
    v_dot2_f32_bf16 v19, v73, s54, v19
    v_dot2_f32_bf16 v20, v74, s53, v20
    v_dot2_f32_bf16 v21, v74, s54, v21
    v_dot2_f32_bf16 v22, v75, s53, v22
    v_dot2_f32_bf16 v23, v75, s54, v23
    v_dot2_f32_bf16 v16, v76, s53, v16
    v_dot2_f32_bf16 v17, v76, s54, v17
    v_dot2_f32_bf16 v18, v77, s53, v18
    v_dot2_f32_bf16 v19, v77, s54, v19
    v_dot2_f32_bf16 v20, v78, s53, v20
    v_dot2_f32_bf16 v21, v78, s54, v21
    v_dot2_f32_bf16 v22, v79, s53, v22
    v_dot2_f32_bf16 v23, v79, s54, v23
    v_dot2_f32_bf16 v16, v80, s53, v16
    v_dot2_f32_bf16 v17, v80, s54, v17
    v_dot2_f32_bf16 v18, v81, s53, v18
    v_dot2_f32_bf16 v19, v81, s54, v19
    v_dot2_f32_bf16 v20, v82, s53, v20
    v_dot2_f32_bf16 v21, v82, s54, v21
    v_dot2_f32_bf16 v22, v83, s53, v22
    v_dot2_f32_bf16 v23, v83, s54, v23
    v_dot2_f32_bf16 v16, v84, s53, v16
    v_dot2_f32_bf16 v17, v84, s54, v17
    v_dot2_f32_bf16 v18, v85, s53, v18
    v_dot2_f32_bf16 v19, v85, s54, v19
    v_dot2_f32_bf16 v20, v86, s53, v20
    v_dot2_f32_bf16 v21, v86, s54, v21
    v_dot2_f32_bf16 v22, v87, s53, v22
    v_dot2_f32_bf16 v23, v87, s54, v23
    v_dot2_f32_bf16 v16, v88, s53, v16
    v_dot2_f32_bf16 v17, v88, s54, v17
    v_dot2_f32_bf16 v18, v89, s53, v18
    v_dot2_f32_bf16 v19, v89, s54, v19
    v_dot2_f32_bf16 v20, v90, s53, v20
    v_dot2_f32_bf16 v21, v90, s54, v21
    v_dot2_f32_bf16 v22, v91, s53, v22
    v_dot2_f32_bf16 v23, v91, s54, v23
    v_dot2_f32_bf16 v16, v92, s53, v16
    v_dot2_f32_bf16 v17, v92, s54, v17
    v_dot2_f32_bf16 v18, v93, s53, v18
    v_dot2_f32_bf16 v19, v93, s54, v19
    v_dot2_f32_bf16 v20, v94, s53, v20
    v_dot2_f32_bf16 v21, v94, s54, v21
    v_dot2_f32_bf16 v22, v95, s53, v22
    v_dot2_f32_bf16 v23, v95, s54, v23
    v_dot2_f32_bf16 v16, v96, s53, v16
    v_dot2_f32_bf16 v17, v96, s54, v17
    v_dot2_f32_bf16 v18, v97, s53, v18
    v_dot2_f32_bf16 v19, v97, s54, v19
    v_dot2_f32_bf16 v20, v98, s53, v20
    v_dot2_f32_bf16 v21, v98, s54, v21
    v_dot2_f32_bf16 v22, v99, s53, v22
    v_dot2_f32_bf16 v23, v99, s54, v23
    v_dot2_f32_bf16 v16, v100, s53, v16
    v_dot2_f32_bf16 v17, v100, s54, v17
    v_dot2_f32_bf16 v18, v101, s53, v18
    v_dot2_f32_bf16 v19, v101, s54, v19
    v_dot2_f32_bf16 v20, v102, s53, v20
    v_dot2_f32_bf16 v21, v102, s54, v21
    v_dot2_f32_bf16 v22, v103, s53, v22
    v_dot2_f32_bf16 v23, v103, s54, v23
    v_dot2_f32_bf16 v16, v104, s53, v16
    v_dot2_f32_bf16 v17, v104, s54, v17
    v_dot2_f32_bf16 v18, v105, s53, v18
    v_dot2_f32_bf16 v19, v105, s54, v19
    v_dot2_f32_bf16 v20, v106, s53, v20
    v_dot2_f32_bf16 v21, v106, s54, v21
    v_dot2_f32_bf16 v22, v107, s53, v22
    v_dot2_f32_bf16 v23, v107, s54, v23
    v_dot2_f32_bf16 v16, v108, s53, v16
    v_dot2_f32_bf16 v17, v108, s54, v17
    v_dot2_f32_bf16 v18, v109, s53, v18
    v_dot2_f32_bf16 v19, v109, s54, v19
    v_dot2_f32_bf16 v20, v110, s53, v20
    v_dot2_f32_bf16 v21, v110, s54, v21
    v_dot2_f32_bf16 v22, v111, s53, v22
    v_dot2_f32_bf16 v23, v111, s54, v23
    v_dot2_f32_bf16 v16, v112, s53, v16
    v_dot2_f32_bf16 v17, v112, s54, v17
    v_dot2_f32_bf16 v18, v113, s53, v18
    v_dot2_f32_bf16 v19, v113, s54, v19
    v_dot2_f32_bf16 v20, v114, s53, v20
    v_dot2_f32_bf16 v21, v114, s54, v21
    v_dot2_f32_bf16 v22, v115, s53, v22
    v_dot2_f32_bf16 v23, v115, s54, v23
    v_dot2_f32_bf16 v16, v116, s53, v16
    v_dot2_f32_bf16 v17, v116, s54, v17
    v_dot2_f32_bf16 v18, v117, s53, v18
    v_dot2_f32_bf16 v19, v117, s54, v19
    v_dot2_f32_bf16 v20, v118, s53, v20
    v_dot2_f32_bf16 v21, v118, s54, v21
    v_dot2_f32_bf16 v22, v119, s53, v22
    v_dot2_f32_bf16 v23, v119, s54, v23
    v_dot2_f32_bf16 v16, v120, s53, v16
    v_dot2_f32_bf16 v17, v120, s54, v17
    v_dot2_f32_bf16 v18, v121, s53, v18
    v_dot2_f32_bf16 v19, v121, s54, v19
    v_dot2_f32_bf16 v20, v122, s53, v20
    v_dot2_f32_bf16 v21, v122, s54, v21
    v_dot2_f32_bf16 v22, v123, s53, v22
    v_dot2_f32_bf16 v23, v123, s54, v23
    v_dot2_f32_bf16 v16, v124, s53, v16
    v_dot2_f32_bf16 v17, v124, s54, v17
    v_dot2_f32_bf16 v18, v125, s53, v18
    v_dot2_f32_bf16 v19, v125, s54, v19
    v_dot2_f32_bf16 v20, v126, s53, v20
    v_dot2_f32_bf16 v21, v126, s54, v21
    v_dot2_f32_bf16 v22, v127, s53, v22
    v_dot2_f32_bf16 v23, v127, s54, v23
    v_dot2_f32_bf16 v16, v128, s53, v16
    v_dot2_f32_bf16 v17, v128, s54, v17
    v_dot2_f32_bf16 v18, v129, s53, v18
    v_dot2_f32_bf16 v19, v129, s54, v19
    v_dot2_f32_bf16 v20, v130, s53, v20
    v_dot2_f32_bf16 v21, v130, s54, v21
    v_dot2_f32_bf16 v22, v131, s53, v22
    v_dot2_f32_bf16 v23, v131, s54, v23
    v_dot2_f32_bf16 v16, v132, s53, v16
    v_dot2_f32_bf16 v17, v132, s54, v17
    v_dot2_f32_bf16 v18, v133, s53, v18
    v_dot2_f32_bf16 v19, v133, s54, v19
    v_dot2_f32_bf16 v20, v134, s53, v20
    v_dot2_f32_bf16 v21, v134, s54, v21
    v_dot2_f32_bf16 v22, v135, s53, v22
    v_dot2_f32_bf16 v23, v135, s54, v23
    v_dot2_f32_bf16 v16, v136, s53, v16
    v_dot2_f32_bf16 v17, v136, s54, v17
    v_dot2_f32_bf16 v18, v137, s53, v18
    v_dot2_f32_bf16 v19, v137, s54, v19
    v_dot2_f32_bf16 v20, v138, s53, v20
    v_dot2_f32_bf16 v21, v138, s54, v21
    v_dot2_f32_bf16 v22, v139, s53, v22
    v_dot2_f32_bf16 v23, v139, s54, v23
    v_dot2_f32_bf16 v16, v140, s53, v16
    v_dot2_f32_bf16 v17, v140, s54, v17
    v_dot2_f32_bf16 v18, v141, s53, v18
    v_dot2_f32_bf16 v19, v141, s54, v19
    v_dot2_f32_bf16 v20, v142, s53, v20
    v_dot2_f32_bf16 v21, v142, s54, v21
    v_dot2_f32_bf16 v22, v143, s53, v22
    v_dot2_f32_bf16 v23, v143, s54, v23
    v_add_f32_dpp v16, v16, v16 row_ror:8 row_mask:0xf bank_mask:0xf
    v_add_f32_dpp v17, v17, v17 row_ror:8 row_mask:0xf bank_mask:0xf
    v_add_f32_dpp v18, v18, v18 row_ror:8 row_mask:0xf bank_mask:0xf
    v_add_f32_dpp v19, v19, v19 row_ror:8 row_mask:0xf bank_mask:0xf
    v_add_f32_dpp v20, v20, v20 row_ror:8 row_mask:0xf bank_mask:0xf
    v_add_f32_dpp v21, v21, v21 row_ror:8 row_mask:0xf bank_mask:0xf
    v_add_f32_dpp v22, v22, v22 row_ror:8 row_mask:0xf bank_mask:0xf
    v_add_f32_dpp v23, v23, v23 row_ror:8 row_mask:0xf bank_mask:0xf
    v_mov_b32 v24, v16
    v_mov_b32 v25, v17
    v_mov_b32 v26, v18
    v_mov_b32 v27, v19
    v_mov_b32 v28, v20
    v_mov_b32 v29, v21
    v_mov_b32 v30, v22
    v_mov_b32 v31, v23
    v_permlane16_swap_b32 v16, v24
    v_permlane16_swap_b32 v17, v25
    v_permlane16_swap_b32 v18, v26
    v_permlane16_swap_b32 v19, v27
    v_permlane16_swap_b32 v20, v28
    v_permlane16_swap_b32 v21, v29
    v_permlane16_swap_b32 v22, v30
    v_permlane16_swap_b32 v23, v31
    v_add_f32 v16, v16, v24
    v_add_f32 v17, v17, v25
    v_add_f32 v18, v18, v26
    v_add_f32 v19, v19, v27
    v_add_f32 v20, v20, v28
    v_add_f32 v21, v21, v29
    v_add_f32 v22, v22, v30
    v_add_f32 v23, v23, v31
    v_mov_b32 v24, v16
    v_mov_b32 v25, v17
    v_mov_b32 v26, v18
    v_mov_b32 v27, v19
    v_mov_b32 v28, v20
    v_mov_b32 v29, v21
    v_mov_b32 v30, v22
    v_mov_b32 v31, v23
    v_permlane32_swap_b32 v16, v24
    v_permlane32_swap_b32 v17, v25
    v_permlane32_swap_b32 v18, v26
    v_permlane32_swap_b32 v19, v27
    v_permlane32_swap_b32 v20, v28
    v_permlane32_swap_b32 v21, v29
    v_permlane32_swap_b32 v22, v30
    v_permlane32_swap_b32 v23, v31
    v_add_f32 v16, v16, v24
    v_add_f32 v17, v17, v25
    v_add_f32 v18, v18, v26
    v_add_f32 v19, v19, v27
    v_add_f32 v20, v20, v28
    v_add_f32 v21, v21, v29
    v_add_f32 v22, v22, v30
    v_add_f32 v23, v23, v31
    s_lshl_b32 s12, s3, 8
    s_sub_u32 s12, s12, 768
    v_lshl_add_u32 v10, v3, 5, s12
    ds_write_b128 v10, v[16:19]
    ds_write_b128 v10, v[20:23] offset:16
    s_waitcnt lgkmcnt(0)
    s_barrier
    s_cmp_lg_u32 s3, 4
    s_cbranch_scc1 L1_sdone
    s_cmp_ge_u32 s5, 4
    s_cbranch_scc1 L1_sdone
    v_lshlrev_b32 v10, 2, v1
    ds_read_b32 v16, v10 offset:256
    ds_read_b32 v17, v10 offset:512
    ds_read_b32 v18, v10 offset:768
    ds_read_b32 v19, v10 offset:1024
    s_mul_i32 s12, s7, 1536
    s_add_u32 s12, s12, s8
    s_lshl_b32 s12, s12, 2
    s_add_u32 s12, s12, 32768
    v_add_u32 v10, s12, v10
    s_waitcnt lgkmcnt(0)
    v_add_f32 v16, v16, v17
    v_add_f32 v18, v18, v19
    v_add_f32 v16, v16, v18
    global_store_dword v10, v16, s[42:43] sc1
    v_mov_b32 v10, 10699008
    v_mov_b32 v11, 1
    s_mov_b64 exec, 1
    s_waitcnt vmcnt(0)
    global_atomic_add v10, v11, s[42:43] sc1
    s_mov_b64 exec, -1
    s_branch L1_sdone
L1_w2:
    v_lshrrev_b32_e64 v10, 4, v1
    v_bfe_u32 v11, v1, 3, 1
    v_bfe_u32 v12, v1, 1, 2
    v_lshl_add_u32 v11, v11, 3, v12
    v_and_b32 v12, 1, v1
    v_lshlrev_b32 v12, 4, v12
    s_and_b32 s12, s4, 1
    s_lshl_b32 s12, s12, 2
    s_add_u32 s12, s12, s3
    s_lshr_b32 s13, s4, 1
    s_mul_i32 s14, s12, 160
    s_mul_i32 s15, s13, 40960
    s_add_u32 s14, s14, s15
    s_mul_i32 s15, s3, 5120
    s_add_u32 s15, s15, 4096
    s_mov_b32 m0, s15
    v_add_u32 v13, 0, v10
    v_mul_u32_u24 v14, 52, v13
    v_lshrrev_b32 v14, 8, v14
    v_mad_i32_i24 v13, v14, -5, v13
    v_and_b32 v15, 1, v14
    v_lshrrev_b32 v14, 1, v14
    v_lshlrev_b32 v14, 4, v14
    v_lshl_add_u32 v14, v15, 2, v14
    v_add_u32 v14, v14, v11
    v_mul_u32_u24 v14, 1280, v14
    v_lshl_add_u32 v14, v13, 5, v14
    v_add_u32 v14, v14, v12
    buffer_load_dwordx4 v14, s[56:59], s14 offen lds
    s_add_u32 m0, m0, 1024
    v_add_u32 v13, 4, v10
    v_mul_u32_u24 v14, 52, v13
    v_lshrrev_b32 v14, 8, v14
    v_mad_i32_i24 v13, v14, -5, v13
    v_and_b32 v15, 1, v14
    v_lshrrev_b32 v14, 1, v14
    v_lshlrev_b32 v14, 4, v14
    v_lshl_add_u32 v14, v15, 2, v14
    v_add_u32 v14, v14, v11
    v_mul_u32_u24 v14, 1280, v14
    v_lshl_add_u32 v14, v13, 5, v14
    v_add_u32 v14, v14, v12
    buffer_load_dwordx4 v14, s[56:59], s14 offen lds
    s_add_u32 m0, m0, 1024
    v_add_u32 v13, 8, v10
    v_mul_u32_u24 v14, 52, v13
    v_lshrrev_b32 v14, 8, v14
    v_mad_i32_i24 v13, v14, -5, v13
    v_and_b32 v15, 1, v14
    v_lshrrev_b32 v14, 1, v14
    v_lshlrev_b32 v14, 4, v14
    v_lshl_add_u32 v14, v15, 2, v14
    v_add_u32 v14, v14, v11
    v_mul_u32_u24 v14, 1280, v14
    v_lshl_add_u32 v14, v13, 5, v14
    v_add_u32 v14, v14, v12
    buffer_load_dwordx4 v14, s[56:59], s14 offen lds
    s_add_u32 m0, m0, 1024
    v_add_u32 v13, 12, v10
    v_mul_u32_u24 v14, 52, v13
    v_lshrrev_b32 v14, 8, v14
    v_mad_i32_i24 v13, v14, -5, v13
    v_and_b32 v15, 1, v14
    v_lshrrev_b32 v14, 1, v14
    v_lshlrev_b32 v14, 4, v14
    v_lshl_add_u32 v14, v15, 2, v14
    v_add_u32 v14, v14, v11
    v_mul_u32_u24 v14, 1280, v14
    v_lshl_add_u32 v14, v13, 5, v14
    v_add_u32 v14, v14, v12
    buffer_load_dwordx4 v14, s[56:59], s14 offen lds
    s_add_u32 m0, m0, 1024
    v_add_u32 v13, 16, v10
    v_mul_u32_u24 v14, 52, v13
    v_lshrrev_b32 v14, 8, v14
    v_mad_i32_i24 v13, v14, -5, v13
    v_and_b32 v15, 1, v14
    v_lshrrev_b32 v14, 1, v14
    v_lshlrev_b32 v14, 4, v14
    v_lshl_add_u32 v14, v15, 2, v14
    v_add_u32 v14, v14, v11
    v_mul_u32_u24 v14, 1280, v14
    v_lshl_add_u32 v14, v13, 5, v14
    v_add_u32 v14, v14, v12
    buffer_load_dwordx4 v14, s[56:59], s14 offen lds
    s_add_u32 m0, m0, 1024
    s_mul_i32 s64, s13, 43
    s_lshr_b32 s64, s64, 7
    s_mul_i32 s65, s64, 3
    s_sub_u32 s65, s13, s65
    s_lshl1_add_u32 s66, s64, s65
    s_add_u32 s66, s66, 15
    s_cmp_eq_u32 s65, 0
    s_cselect_b32 s13, s64, s66
    s_mul_i32 s12, s12, 48
    s_add_u32 s12, s12, s13
    s_mul_i32 s12, s12, 5120
    s_add_u32 s12, s12, 16777216
    v_lshl_add_u32 v13, v1, 4, s12
    v_lshrrev_b32_e64 v14, 5, v1
    v_mul_u32_u24 v14, 2560, v14
    v_bfe_u32 v15, v1, 4, 1
    v_lshl_add_u32 v14, v15, 7, v14
    v_lshl_add_u32 v14, v208, 3, v14
    v_add_u32 v14, s15, v14
    s_waitcnt vmcnt(0)
    ds_read_b64_tr_b16 v[96:97], v14 offset:0
    ds_read_b64_tr_b16 v[98:99], v14 offset:1280
    ds_read_b64_tr_b16 v[100:101], v14 offset:256
    ds_read_b64_tr_b16 v[102:103], v14 offset:1536
    ds_read_b64_tr_b16 v[104:105], v14 offset:512
    ds_read_b64_tr_b16 v[106:107], v14 offset:1792
    ds_read_b64_tr_b16 v[108:109], v14 offset:768
    ds_read_b64_tr_b16 v[110:111], v14 offset:2048
    ds_read_b64_tr_b16 v[112:113], v14 offset:1024
    ds_read_b64_tr_b16 v[114:115], v14 offset:2304
    s_waitcnt lgkmcnt(8)
    global_store_dwordx4 v13, v[96:99], s[42:43] offset:0 sc1
    s_waitcnt lgkmcnt(6)
    global_store_dwordx4 v13, v[100:103], s[42:43] offset:1024 sc1
    s_waitcnt lgkmcnt(4)
    global_store_dwordx4 v13, v[104:107], s[42:43] offset:2048 sc1
    s_waitcnt lgkmcnt(2)
    global_store_dwordx4 v13, v[108:111], s[42:43] offset:3072 sc1
    s_waitcnt lgkmcnt(0)
    v_add_u32 v13, 4096, v13
    global_store_dwordx4 v13, v[112:115], s[42:43] sc1
    s_waitcnt vmcnt(0)
    s_barrier
L1_sdone:
    s_mov_b32 s69, 0
    s_cmp_ge_u32 s3, 4
    s_cbranch_scc1 LF_L
    s_cmp_lg_u32 s3, 0
    s_cbranch_scc1 LF_C
    v_mov_b32 v2, 10703360
    v_mov_b32 v3, 1
    s_mov_b64 exec, 1
    global_atomic_add v2, v3, s[42:43] sc1
    s_mov_b64 exec, -1
    s_branch LF_C
LF_G:
    s_setprio 0
    s_mov_b32 s69, 1
LF_L:
    s_setprio 0
    s_and_b32 s6, s2, 3
    s_lshl_b32 s6, s6, 2
    s_bfe_u32 s7, s2, 0x20003
    s_add_u32 s6, s6, s7
    s_bfe_u32 s7, s2, 0x10002
    s_lshl_b32 s7, s7, 3
    s_lshr_b32 s5, s2, 5
    s_add_u32 s7, s7, s5
    s_sub_u32 s3, s3, 4
    s_load_dwordx4 s[36:39], s[0:1], 80
    v_lshlrev_b32 v10, 4, v1
    v_bfe_u32 v4, v1, 2, 2
    v_and_b32 v5, 3, v1
    v_lshrrev_b32 v3, 4, v1
    s_and_b32 s9, s3, 1
    s_mul_i32 s8, s9, 12
    v_add_u32 v2, s8, v3
    s_mul_i32 s10, s6, 192
    v_add_u32 v6, 0, v2
    v_mul_u32_u24 v7, 43, v6
    v_lshrrev_b32 v7, 7, v7
    v_mad_i32_i24 v8, v7, -3, v6
    v_and_b32 v9, 2, v7
    v_xor_b32_e64 v9, v9, v5
    v_lshl_add_u32 v7, v7, 2, v4
    v_mul_u32_u24 v7, 3072, v7
    v_lshl_add_u32 v7, v8, 6, v7
    v_lshl_add_u32 v7, v9, 4, v7
    v_add_u32 v60, s10, v7
    v_add_u32 v6, 4, v2
    v_mul_u32_u24 v7, 43, v6
    v_lshrrev_b32 v7, 7, v7
    v_mad_i32_i24 v8, v7, -3, v6
    v_and_b32 v9, 2, v7
    v_xor_b32 v9, v9, v5
    v_lshl_add_u32 v7, v7, 2, v4
    v_mul_u32_u24 v7, 3072, v7
    v_lshl_add_u32 v7, v8, 6, v7
    v_lshl_add_u32 v7, v9, 4, v7
    v_add_u32 v61, s10, v7
    v_add_u32 v6, 8, v2
    v_mul_u32_u24 v7, 43, v6
    v_lshrrev_b32 v7, 7, v7
    v_mad_i32_i24 v8, v7, -3, v6
    v_and_b32 v9, 2, v7
    v_xor_b32 v9, v9, v5
    v_lshl_add_u32 v7, v7, 2, v4
    v_mul_u32_u24 v7, 3072, v7
    v_lshl_add_u32 v7, v8, 6, v7
    v_lshl_add_u32 v7, v9, 4, v7
    v_add_u32 v62, s10, v7
    v_subrev_u32 v61, 1024, v61
    v_subrev_u32 v62, 2048, v62
    s_mul_i32 s20, s3, 3072
    s_mov_b32 s26, 0
    s_mov_b32 s48, s42
    s_mov_b32 s49, s43
    s_mov_b32 s50, 18743296
    s_mov_b32 s51, 0x20000
    s_mov_b32 s54, 1966080
    s_mov_b32 s55, 0x20000
    s_mov_b32 s28, s20
    s_cmp_ge_u32 s3, 2
    s_waitcnt lgkmcnt(0)
    s_cselect_b32 s52, s38, s36
    s_cselect_b32 s53, s39, s37
    s_branch LF_go1
LF_dw:
    s_mov_b32 m0, s28
    s_add_u32 s28, s28, 12288
    buffer_load_dwordx4 v60, s[52:55], s26 offen  lds
    buffer_load_dwordx4 v61, s[52:55], s26 offen offset:1024  lds
    buffer_load_dwordx4 v62, s[52:55], s26 offen offset:2048  lds
    s_add_u32 s26, s26, 98304
    s_cmp_ge_u32 s28, 110592
    s_cselect_b32 s28, s20, s28
    s_setpc_b64 s[70:71]
LF_dt:
    s_mov_b32 m0, s29
    s_add_u32 s29, s29, 1024
    buffer_load_dwordx4 v13, s[48:51], s27 offen sc1 lds
    s_mov_b32 m0, s29
    s_add_u32 s29, s29, 7168
    buffer_load_dwordx4 v14, s[48:51], s27 offen sc1 lds
    s_add_u32 s27, s27, 131072
    s_cmp_ge_u32 s29, 159744
    s_cselect_b32 s29, s23, s29
    s_setpc_b64 s[70:71]
LF_go1:
    s_call_b64 s[70:71], LF_dw
    s_call_b64 s[70:71], LF_dw
    s_call_b64 s[70:71], LF_dw
    s_call_b64 s[70:71], LF_dw
    s_call_b64 s[70:71], LF_dw
    s_call_b64 s[70:71], LF_dw
    s_lshl_b32 s8, s3, 3
    v_add_u32 v6, s8, v4
    v_lshlrev_b32 v6, 12, v6
    v_lshl_add_u32 v6, v3, 6, v6
    s_and_b32 s9, s3, 1
    s_lshl_b32 s8, s9, 1
    v_xor_b32 v7, s8, v5
    v_lshl_add_u32 v6, v7, 4, v6
    s_lshl_b32 s8, s7, 8
    v_add_u32 v13, s8, v6
    v_add_u32 v14, 16384, v13
    s_lshl_b32 s23, s3, 11
    s_add_u32 s23, s23, 110592
    s_mov_b32 s29, s23
    s_mov_b32 s27, 1048576
    v_lshrrev_b32 v2, 2, v1
    s_mul_i32 s8, s6, 40
    v_add_u32 v15, s8, v2
    v_lshlrev_b32 v15, 12, v15
    v_lshl_add_u32 v15, v5, 4, v15
    s_lshl_b32 s8, s7, 8
    s_lshl_b32 s9, s3, 6
    s_add_u32 s8, s8, s9
    v_add_u32 v15, s8, v15
    v_lshrrev_b32 v6, 5, v1
    v_lshl_or_b32 v16, v6, 30, v15
    v_lshlrev_b32_e64 v17, 9, v6
    v_lshl_add_u32 v17, v5, 5, v17
    v_bfe_u32 v7, v1, 4, 1
    v_lshl_add_u32 v17, v7, 4, v17
    s_lshl_b32 s8, s7, 4
    s_add_u32 s9, s8, s6
    s_lshl_b32 s9, s9, 10
    s_lshl_b32 s10, s3, 7
    s_add_u32 s9, s9, s10
    s_add_u32 s9, s9, 262144
    v_add_u32 v17, s9, v17
    s_mul_i32 s9, s7, 4352
    s_add_u32 s9, s9, 10485760
    v_mov_b32 v18, s9
    v_mov_b32 v19, 1
    v_add_u32 v20, s8, v3
    v_lshlrev_b32 v20, 10, v20
    v_bfe_u32 v6, v1, 3, 1
    v_lshl_add_u32 v20, v6, 9, v20
    v_and_b32 v6, 7, v1
    v_lshl_add_u32 v20, v6, 4, v20
    s_add_u32 s9, s10, 262144
    v_add_u32 v20, s9, v20
    v_add_u32 v21, 8192, v20
    v_add_u32 v40, 4096, v20
    v_add_u32 v41, 4096, v21
    v_lshl_add_u32 v22, v6, 2, v3
    s_lshl_b32 s9, s3, 5
    v_add_u32 v22, s9, v22
    v_lshlrev_b32 v22, 4, v22
    v_add_u32 v22, 161792, v22
    v_cmp_lt_u32 vcc, 23, v1
    v_mov_b32 v6, 5760
    s_mul_i32 s9, s6, 384
    s_add_u32 s9, s9, 32768
    v_cndmask_b32 v6, 0, v6, vcc
    v_add3_u32 v42, v10, v6, s9
    v_add_u32 v43, 159744, v10
    s_and_b32 s9, s2, 1
    s_lshl_b32 s9, s9, 2
    v_and_b32 v44, 3, v1
    v_add_u32 v44, s9, v44
    v_mul_u32_u24 v44, 4352, v44
    v_add_u32 v44, 10729472, v44
    s_mov_b32 s11, 1048576
    s_mov_b32 s12, 1114112
    s_mov_b32 s13, 1179648
    s_and_b32 s56, s2, 1
    s_lshl_b32 s56, s56, 2
    s_bfe_u32 s57, s2, 0x20003
    s_add_u32 s56, s56, s57
    s_bfe_u32 s57, s2, 0x20001
    s_lshl_b32 s57, s57, 3
    s_lshr_b32 s5, s2, 5
    s_add_u32 s57, s57, s5
    s_mul_i32 s58, s3, 5120
    s_mov_b32 s59, s58
    s_mul_i32 s60, s56, 245760
    s_add_u32 s60, s60, s58
    s_add_u32 s60, s60, 16777216
    s_cmp_lt_u32 s3, 2
    s_cselect_b32 s24, 1, 0
    v_lshrrev_b32 v6, 5, v1
    v_bfe_u32 v7, v1, 1, 2
    v_lshl_add_u32 v6, v6, 2, v7
    v_lshlrev_b32 v6, 12, v6
    v_bfe_u32 v7, v1, 3, 2
    v_lshl_add_u32 v6, v7, 5, v6
    v_and_b32 v7, 1, v1
    v_lshl_add_u32 v6, v7, 4, v6
    s_mul_i32 s8, s56, 327680
    s_lshl_b32 s9, s57, 7
    s_add_u32 s8, s8, s9
    s_add_u32 s8, s8, 1048576
    v_add_u32 v63, s8, v6
    s_cmp_eq_u32 s69, 0
    s_cbranch_scc1 LF_l2
    s_barrier
LF_l2:
    s_call_b64 s[70:71], LF_dw
    s_call_b64 s[70:71], LF_dw
    s_call_b64 s[70:71], LF_dw
    s_cmp_lg_u32 s3, 0
    s_cbranch_scc1 LF_l4
LF_p1:
    global_load_dword v12, v44, s[42:43] sc1
    s_waitcnt vmcnt(0)
    v_cmp_ne_u32 vcc, 1, v12
    s_cbranch_vccz LF_p1d
    s_sleep 2
    s_branch LF_p1
LF_p1d:
LF_l4:
    s_waitcnt vmcnt(24)
    s_barrier
    s_call_b64 s[70:71], LF_dt
    s_call_b64 s[70:71], LF_dt
    buffer_load_dwordx4 v[48:51], v15, s[48:51], s11 offen sc1
    buffer_load_dwordx4 v[52:55], v15, s[48:51], s12 offen sc1
    buffer_load_dwordx4 v[56:59], v16, s[48:51], s13 offen sc1
    s_call_b64 s[70:71], LF_dt
    s_call_b64 s[70:71], LF_dt
    s_call_b64 s[70:71], LF_dt
    s_call_b64 s[70:71], LF_dt
    s_waitcnt vmcnt(13)
    s_barrier
    s_waitcnt vmcnt(6)
    s_barrier
    s_call_b64 s[70:71], LF_dt
    s_call_b64 s[70:71], LF_dw
    v_lshlrev_b32 v80, 16, v48
    v_and_b32 v81, 0xffff0000, v48
    v_lshlrev_b32 v82, 16, v49
    v_and_b32 v83, 0xffff0000, v49
    v_lshlrev_b32 v84, 16, v50
    v_and_b32 v85, 0xffff0000, v50
    v_lshlrev_b32 v86, 16, v51
    v_and_b32 v87, 0xffff0000, v51
    v_mov_b32 v64, v80
    v_mul_f32 v72, v80, v80
    v_mov_b32 v65, v81
    v_mul_f32 v73, v81, v81
    v_mov_b32 v66, v82
    v_mul_f32 v74, v82, v82
    v_mov_b32 v67, v83
    v_mul_f32 v75, v83, v83
    v_mov_b32 v68, v84
    v_mul_f32 v76, v84, v84
    v_mov_b32 v69, v85
    v_mul_f32 v77, v85, v85
    v_mov_b32 v70, v86
    v_mul_f32 v78, v86, v86
    v_mov_b32 v71, v87
    v_mul_f32 v79, v87, v87
    v_lshlrev_b32 v80, 16, v52
    v_and_b32 v81, 0xffff0000, v52
    v_lshlrev_b32 v82, 16, v53
    v_and_b32 v83, 0xffff0000, v53
    v_lshlrev_b32 v84, 16, v54
    v_and_b32 v85, 0xffff0000, v54
    v_lshlrev_b32 v86, 16, v55
    v_and_b32 v87, 0xffff0000, v55
    v_add_f32 v64, v64, v80
    v_fmac_f32 v72, v80, v80
    v_add_f32 v65, v65, v81
    v_fmac_f32 v73, v81, v81
    v_add_f32 v66, v66, v82
    v_fmac_f32 v74, v82, v82
    v_add_f32 v67, v67, v83
    v_fmac_f32 v75, v83, v83
    v_add_f32 v68, v68, v84
    v_fmac_f32 v76, v84, v84
    v_add_f32 v69, v69, v85
    v_fmac_f32 v77, v85, v85
    v_add_f32 v70, v70, v86
    v_fmac_f32 v78, v86, v86
    v_add_f32 v71, v71, v87
    v_fmac_f32 v79, v87, v87
    v_lshlrev_b32 v80, 16, v56
    v_and_b32 v81, 0xffff0000, v56
    v_lshlrev_b32 v82, 16, v57
    v_and_b32 v83, 0xffff0000, v57
    v_lshlrev_b32 v84, 16, v58
    v_and_b32 v85, 0xffff0000, v58
    v_lshlrev_b32 v86, 16, v59
    v_and_b32 v87, 0xffff0000, v59
    v_add_f32 v64, v64, v80
    v_fmac_f32 v72, v80, v80
    v_add_f32 v65, v65, v81
    v_fmac_f32 v73, v81, v81
    v_add_f32 v66, v66, v82
    v_fmac_f32 v74, v82, v82
    v_add_f32 v67, v67, v83
    v_fmac_f32 v75, v83, v83
    v_add_f32 v68, v68, v84
    v_fmac_f32 v76, v84, v84
    v_add_f32 v69, v69, v85
    v_fmac_f32 v77, v85, v85
    v_add_f32 v70, v70, v86
    v_fmac_f32 v78, v86, v86
    v_add_f32 v71, v71, v87
    v_fmac_f32 v79, v87, v87
    s_waitcnt vmcnt(7)
    s_barrier
    s_call_b64 s[70:71], LF_dt
    s_call_b64 s[70:71], LF_dt
    s_call_b64 s[70:71], LF_dw
    s_call_b64 s[70:71], LF_dw
    v_permlane32_swap_b32 v64, v72
    v_permlane32_swap_b32 v65, v73
    v_permlane32_swap_b32 v66, v74
    v_permlane32_swap_b32 v67, v75
    v_permlane32_swap_b32 v68, v76
    v_permlane32_swap_b32 v69, v77
    v_permlane32_swap_b32 v70, v78
    v_permlane32_swap_b32 v71, v79
    v_add_f32 v64, v64, v72
    v_add_f32 v65, v65, v73
    v_add_f32 v66, v66, v74
    v_add_f32 v67, v67, v75
    v_add_f32 v68, v68, v76
    v_add_f32 v69, v69, v77
    v_add_f32 v70, v70, v78
    v_add_f32 v71, v71, v79
    v_permlane16_swap_b32 v64, v68
    v_permlane16_swap_b32 v65, v69
    v_permlane16_swap_b32 v66, v70
    v_permlane16_swap_b32 v67, v71
    v_add_f32 v64, v64, v68
    v_add_f32 v65, v65, v69
    v_add_f32 v66, v66, v70
    v_add_f32 v67, v67, v71
    v_add_f32_dpp v64, v64, v64 row_ror:8 row_mask:0xf bank_mask:0xf
    v_add_f32_dpp v65, v65, v65 row_ror:8 row_mask:0xf bank_mask:0xf
    v_add_f32_dpp v66, v66, v66 row_ror:8 row_mask:0xf bank_mask:0xf
    v_add_f32_dpp v67, v67, v67 row_ror:8 row_mask:0xf bank_mask:0xf
    v_add_f32_dpp v64, v64, v64 row_ror:4 row_mask:0xf bank_mask:0xf
    v_add_f32_dpp v65, v65, v65 row_ror:4 row_mask:0xf bank_mask:0xf
    v_add_f32_dpp v66, v66, v66 row_ror:4 row_mask:0xf bank_mask:0xf
    v_add_f32_dpp v67, v67, v67 row_ror:4 row_mask:0xf bank_mask:0xf
    s_mov_b32 exec_lo, 0x000f000f
    s_mov_b32 exec_hi, 0x000f000f
    global_store_dwordx4 v17, v[64:67], s[42:43] sc1
    s_mov_b64 exec, -1
    v_mov_b32 v46, 10703360
    global_load_dword v45, v46, s[42:43] sc1
    s_waitcnt vmcnt(15)
    s_barrier
    s_call_b64 s[70:71], LF_dt
    s_call_b64 s[70:71], LF_dt
    s_call_b64 s[70:71], LF_dw
    s_call_b64 s[70:71], LF_dw
    s_waitcnt vmcnt(11)
    s_barrier
    s_call_b64 s[70:71], LF_dt
    s_call_b64 s[70:71], LF_dt
    s_call_b64 s[70:71], LF_dw
    s_call_b64 s[70:71], LF_dw
    s_cmp_lg_u32 s3, 0
    s_cbranch_scc1 LF_nsig
    s_mov_b64 exec, 1
    global_atomic_add v18, v19, s[42:43] sc1
    s_mov_b64 exec, -1
LF_nsig:
    s_waitcnt vmcnt(16)
    s_barrier
    s_call_b64 s[70:71], LF_dt
    s_call_b64 s[70:71], LF_dt
    s_call_b64 s[70:71], LF_dw
    s_call_b64 s[70:71], LF_dw
    s_waitcnt vmcnt(16)
    s_barrier
    s_call_b64 s[70:71], LF_dt
    s_call_b64 s[70:71], LF_dt
    s_call_b64 s[70:71], LF_dw
    s_call_b64 s[70:71], LF_dw
    s_waitcnt vmcnt(16)
    s_barrier
    s_call_b64 s[70:71], LF_dt
    s_call_b64 s[70:71], LF_dt
    v_mov_b32 v47, 10699008
    global_load_dword v12, v47, s[42:43] sc1
    global_load_dword v23, v18, s[42:43] sc1
    s_waitcnt vmcnt(46)
    v_cmp_ne_u32 vcc, 0x60, v45
    s_cbranch_vccz LF_p4d
LF_p4:
    global_load_dword v45, v46, s[42:43] sc1
    s_waitcnt vmcnt(0)
    v_cmp_ne_u32 vcc, 0x60, v45
    s_cbranch_vccz LF_p4d
    s_sleep 4
    s_branch LF_p4
LF_p4d:
    s_add_u32 s61, s60, 143360
    s_add_u32 s31, s61, 4096
    buffer_load_dwordx4 v[100:103], v10, s[48:51], s61 offen offset:0 sc1
    buffer_load_dwordx4 v[104:107], v10, s[48:51], s61 offen offset:1024 sc1
    buffer_load_dwordx4 v[108:111], v10, s[48:51], s61 offen offset:2048 sc1
    buffer_load_dwordx4 v[112:115], v10, s[48:51], s61 offen offset:3072 sc1
    buffer_load_dwordx4 v[116:119], v10, s[48:51], s31 offen offset:0 sc1
    s_add_u32 s61, s61, 20480
    s_add_u32 s31, s61, 4096
    buffer_load_dwordx4 v[120:123], v10, s[48:51], s61 offen offset:0 sc1
    buffer_load_dwordx4 v[124:127], v10, s[48:51], s61 offen offset:1024 sc1
    buffer_load_dwordx4 v[128:131], v10, s[48:51], s61 offen offset:2048 sc1
    buffer_load_dwordx4 v[132:135], v10, s[48:51], s61 offen offset:3072 sc1
    buffer_load_dwordx4 v[136:139], v10, s[48:51], s31 offen offset:0 sc1
    s_add_u32 s61, s61, 20480
    s_waitcnt vmcnt(10)
    s_barrier
    s_call_b64 s[70:71], LF_dt
    v_cmp_ne_u32 vcc, 16, v23
    s_cbranch_vccz LF_cnt
LF_p2:
    global_load_dword v23, v18, s[42:43] sc1
    s_waitcnt vmcnt(0)
    v_cmp_ne_u32 vcc, 16, v23
    s_cbranch_vccz LF_p2d
    s_sleep 1
    s_branch LF_p2
LF_p2d:
LF_cnt:
    v_cmp_ne_u32 vcc, 48, v12
    s_cbranch_vccz LF_p5d
LF_p5:
    global_load_dword v12, v47, s[42:43] sc1
    s_waitcnt vmcnt(0)
    v_cmp_ne_u32 vcc, 48, v12
    s_cbranch_vccz LF_p5d
    s_sleep 4
    s_branch LF_p5
LF_p5d:
    global_load_dwordx4 v[48:51], v42, s[42:43] sc1
    global_load_dwordx4 v[24:27], v20, s[42:43] sc1
    global_load_dwordx4 v[28:31], v40, s[42:43] sc1
    global_load_dwordx4 v[32:35], v21, s[42:43] sc1
    global_load_dwordx4 v[36:39], v41, s[42:43] sc1
    s_add_u32 s31, s61, 4096
    buffer_load_dwordx4 v[140:143], v10, s[48:51], s61 offen offset:0 sc1
    buffer_load_dwordx4 v[144:147], v10, s[48:51], s61 offen offset:1024 sc1
    buffer_load_dwordx4 v[148:151], v10, s[48:51], s61 offen offset:2048 sc1
    buffer_load_dwordx4 v[152:155], v10, s[48:51], s61 offen offset:3072 sc1
    buffer_load_dwordx4 v[156:159], v10, s[48:51], s31 offen offset:0 sc1
    s_add_u32 s61, s61, 20480
    s_waitcnt vmcnt(24)
    s_barrier
    s_add_u32 s31, s61, 4096
    buffer_load_dwordx4 v[160:163], v10, s[48:51], s61 offen offset:0 sc1
    buffer_load_dwordx4 v[164:167], v10, s[48:51], s61 offen offset:1024 sc1
    buffer_load_dwordx4 v[168:171], v10, s[48:51], s61 offen offset:2048 sc1
    buffer_load_dwordx4 v[172:175], v10, s[48:51], s61 offen offset:3072 sc1
    buffer_load_dwordx4 v[176:179], v10, s[48:51], s31 offen offset:0 sc1
    s_add_u32 s61, s61, 20480
    s_add_u32 s31, s61, 4096
    buffer_load_dwordx4 v[180:183], v10, s[48:51], s61 offen offset:0 sc1
    buffer_load_dwordx4 v[184:187], v10, s[48:51], s61 offen offset:1024 sc1
    buffer_load_dwordx4 v[188:191], v10, s[48:51], s61 offen offset:2048 sc1
    buffer_load_dwordx4 v[192:195], v10, s[48:51], s61 offen offset:3072 sc1
    buffer_load_dwordx4 v[196:199], v10, s[48:51], s31 offen offset:0 sc1
    s_add_u32 s61, s61, 20480
    s_waitcnt vmcnt(20)
    s_barrier
    s_waitcnt vmcnt(15)
    ds_write_b128 v43, v[48:51]
    v_add_f32 v24, v24, v28
    v_add_f32 v25, v25, v29
    v_add_f32 v26, v26, v30
    v_add_f32 v27, v27, v31
    v_add_f32 v32, v32, v36
    v_add_f32 v33, v33, v37
    v_add_f32 v34, v34, v38
    v_add_f32 v35, v35, v39
    v_add_f32 v24, v24, v32
    v_add_f32 v25, v25, v33
    v_add_f32 v26, v26, v34
    v_add_f32 v27, v27, v35
    s_nop 0
    v_permlane32_swap_b32 v24, v26
    v_permlane32_swap_b32 v25, v27
    v_add_f32 v24, v24, v26
    v_add_f32 v25, v25, v27
    s_nop 1
    v_permlane16_swap_b32 v24, v25
    v_add_f32 v24, v24, v25
    s_nop 1
    v_mov_b32_dpp v25, v24 row_ror:8 row_mask:0xf bank_mask:0xf
    v_mul_f32 v24, 986500301, v24
    v_mul_f32 v25, 986500301, v25
    v_fma_f32 v25, -v24, v24, v25
    v_max_f32 v25, 0, v25
    v_cvt_pk_bf16_f32 v26, v24, v25
    v_lshlrev_b32 v28, 16, v26
    v_and_b32 v26, 0xffff0000, v26
    v_add_f32 v26, 925353388, v26
    v_cvt_pk_bf16_f32 v26, v26, v26
    v_and_b32 v26, 0xffff0000, v26
    v_sqrt_f32 v26, v26
    s_nop 0
    v_cvt_pk_bf16_f32 v26, v26, v26
    v_and_b32 v30, 0xffff0000, v26
    v_rcp_f32 v29, v30
    v_mul_f32 v30, v30, v30
    s_mov_b32 exec_lo, 0x00ff00ff
    s_mov_b32 exec_hi, 0x00ff00ff
    v_mul_f32 v29, 3216550459, v29
    ds_write_b128 v22, v[28:31]
    s_mov_b64 exec, -1
    s_branch LF_go3
LF_dw3:
    s_mov_b32 m0, s28
    s_add_u32 s31, s20, 4096
    buffer_load_dwordx4 v10, s[48:51], s20 offen sc1 lds
    buffer_load_dwordx4 v10, s[48:51], s20 offen offset:1024 sc1 lds
    buffer_load_dwordx4 v10, s[48:51], s20 offen offset:2048 sc1 lds
    buffer_load_dwordx4 v10, s[48:51], s20 offen offset:3072 sc1 lds
    s_add_u32 m0, s28, 4096
    s_add_u32 s28, s28, 20480
    buffer_load_dwordx4 v10, s[48:51], s31 offen sc1 lds
    s_add_u32 s20, s20, 20480
    s_setpc_b64 s[70:71]
LF_go3:
    s_mov_b32 s22, s58
    s_mov_b32 s28, s59
    s_mov_b32 s20, s60
    v_mov_b32 v16, v63
    s_waitcnt lgkmcnt(0)
    s_barrier
    s_mov_b32 s30, 0
LF_pf3:
    s_call_b64 s[70:71], LF_dw3
    s_waitcnt vmcnt(55)
    s_add_u32 s30, s30, 1
    s_cmp_lt_u32 s30, 7
    s_cbranch_scc1 LF_pf3
    s_cmp_eq_u32 s24, 1
    s_cbranch_scc1 LF_nores
    s_sub_u32 s27, s3, 2
    s_mul_i32 s27, s27, 5
    s_lshl_b32 s26, s27, 15
    s_lshl_b32 s27, s27, 10
    s_add_u32 s27, s27, 143360
    s_mov_b32 m0, s27
    s_add_u32 s27, s27, 1024
    buffer_load_dwordx4 v16, s[48:51], s26 offen sc1 lds
    s_add_u32 s26, s26, 32768
    s_mov_b32 m0, s27
    s_add_u32 s27, s27, 1024
    buffer_load_dwordx4 v16, s[48:51], s26 offen sc1 lds
    s_add_u32 s26, s26, 32768
    s_mov_b32 m0, s27
    s_add_u32 s27, s27, 1024
    buffer_load_dwordx4 v16, s[48:51], s26 offen sc1 lds
    s_add_u32 s26, s26, 32768
    s_mov_b32 m0, s27
    s_add_u32 s27, s27, 1024
    buffer_load_dwordx4 v16, s[48:51], s26 offen sc1 lds
    s_add_u32 s26, s26, 32768
    s_mov_b32 m0, s27
    s_add_u32 s27, s27, 1024
    buffer_load_dwordx4 v16, s[48:51], s26 offen sc1 lds
    s_add_u32 s26, s26, 32768
LF_nores:
    v_add_u32 v11, s22, v10
    s_waitcnt vmcnt(25)
    s_barrier
    s_waitcnt vmcnt(10)
    s_barrier
    ds_write_b128 v11, v[100:103] offset:0
    ds_write_b128 v11, v[104:107] offset:1024
    ds_write_b128 v11, v[108:111] offset:2048
    ds_write_b128 v11, v[112:115] offset:3072
    ds_write_b128 v11, v[116:119] offset:4096
    v_add_u32 v11, 20480, v11
    ds_write_b128 v11, v[120:123] offset:0
    ds_write_b128 v11, v[124:127] offset:1024
    ds_write_b128 v11, v[128:131] offset:2048
    ds_write_b128 v11, v[132:135] offset:3072
    ds_write_b128 v11, v[136:139] offset:4096
    v_add_u32 v11, 20480, v11
    s_waitcnt lgkmcnt(0)
    s_waitcnt vmcnt(0)
    s_barrier
    ds_write_b128 v11, v[140:143] offset:0
    ds_write_b128 v11, v[144:147] offset:1024
    ds_write_b128 v11, v[148:151] offset:2048
    ds_write_b128 v11, v[152:155] offset:3072
    ds_write_b128 v11, v[156:159] offset:4096
    v_add_u32 v11, 20480, v11
    ds_write_b128 v11, v[160:163] offset:0
    ds_write_b128 v11, v[164:167] offset:1024
    ds_write_b128 v11, v[168:171] offset:2048
    ds_write_b128 v11, v[172:175] offset:3072
    ds_write_b128 v11, v[176:179] offset:4096
    v_add_u32 v11, 20480, v11
    ds_write_b128 v11, v[180:183] offset:0
    ds_write_b128 v11, v[184:187] offset:1024
    ds_write_b128 v11, v[188:191] offset:2048
    ds_write_b128 v11, v[192:195] offset:3072
    ds_write_b128 v11, v[196:199] offset:4096
    v_add_u32 v11, 20480, v11
    s_waitcnt lgkmcnt(0)
    s_barrier
    s_barrier
    s_endpgm
LF_M:
    s_bfe_u32 s7, s2, 0x20003
    s_mul_i32 s7, s7, 4352
    s_add_u32 s8, s7, 10712064
    v_mov_b32 v2, s8
    v_mov_b32 v3, 1
    v_mul_u32_u24 v5, 17408, v1
    s_add_u32 s8, s7, 10729472
    v_add_u32 v5, s8, v5
    s_mov_b64 exec, 1
    s_waitcnt vmcnt(0)
    ds_add_rtn_u32 v4, v232, v3
    s_waitcnt lgkmcnt(0)
    v_cmp_eq_u32 vcc, 3, v4
    s_cbranch_vccz LF_m2
    global_atomic_add v4, v2, v3, s[42:43] sc0 sc1
    s_waitcnt vmcnt(0)
    v_cmp_eq_u32 vcc, 39, v4
    s_cbranch_vccz LF_m2
    s_mov_b64 exec, 3
    global_store_dword v5, v3, s[42:43] sc1
LF_m2:
    s_mov_b64 exec, -1
    s_barrier
LF_C:
    s_setprio 1
    s_and_b32 s6, s2, 3
    s_lshl_b32 s6, s6, 2
    s_bfe_u32 s7, s2, 0x20003
    s_add_u32 s6, s6, s7
    s_bfe_u32 s7, s2, 0x10002
    s_lshl_b32 s7, s7, 3
    s_lshr_b32 s5, s2, 5
    s_add_u32 s7, s7, s5
    v_lshrrev_b32 v2, 2, v1
    v_and_b32 v4, 3, v1
    v_lshrrev_b32 v5, 5, v1
    v_bfe_u32 v6, v1, 4, 1
    v_and_b32 v8, 15, v1
    v_lshrrev_b32 v9, 4, v1
    v_lshlrev_b32 v10, 6, v2
    v_and_b32 v10, 0xc0, v10
    v_lshl_add_u32 v10, v4, 3, v10
    v_lshl_add_u32 v10, v6, 5, v10
    v_mul_u32_u24 v11, 1536, v9
    v_add_u32 v11, v11, v10
    s_and_b32 s8, s3, 1
    s_lshr_b32 s9, s3, 1
    s_lshl_b32 s10, s8, 5
    v_xor_b32 v12, s10, v11
    v_lshl_add_u32 v13, v9, 11, v10
    s_lshl_b32 s10, s9, 9
    s_add_u32 s10, s10, 110592
    v_add_u32 v13, s10, v13
    v_xor_b32 v14, 32, v13
    s_lshl_b32 s10, s8, 6
    s_add_u32 s10, s10, 159744
    v_lshl_add_u32 v17, v9, 4, s10
    s_lshl_b32 s10, s9, 10
    s_add_u32 s10, s10, 161792
    v_lshl_add_u32 v19, v8, 4, s10
    s_lshl_b32 s10, s7, 3
    s_lshl_b32 s11, s9, 2
    s_add_u32 s10, s10, s11
    s_mul_i32 s10, s10, 49152
    s_mul_i32 s11, s6, 3072
    s_add_u32 s10, s10, s11
    s_lshl_b32 s11, s8, 9
    s_add_u32 s10, s10, s11
    s_add_u32 s10, s10, 4194304
    v_mul_u32_u24 v18, 49152, v6
    v_lshl_add_u32 v18, v5, 8, v18
    v_lshl_add_u32 v18, v8, 4, v18
    v_add_u32 v18, s10, v18
    v_add_u32 v20, 98304, v18
    s_mul_i32 s10, s7, 4352
    s_add_u32 s10, s10, 10555392
    v_mov_b32 v21, s10
    s_lshl_b32 s35, s6, 2
    v_mov_b32 v7, 160768
    v_mov_b64 v[2:3], 0
    ds_write_b64 v7, v[2:3]
    v_mov_b32 v15, 1
    v_mov_b32 v16, 0
    s_load_dwordx2 s[38:39], s[0:1], 104
    v_mov_b64 v[160:161], 0
    v_mov_b64 v[162:163], 0
    v_mov_b64 v[164:165], 0
    v_mov_b64 v[166:167], 0
    v_mov_b64 v[168:169], 0
    v_mov_b64 v[170:171], 0
    v_mov_b64 v[172:173], 0
    v_mov_b64 v[174:175], 0
    v_mov_b64 v[176:177], 0
    v_mov_b64 v[178:179], 0
    v_mov_b64 v[180:181], 0
    v_mov_b64 v[182:183], 0
    v_mov_b64 v[184:185], 0
    v_mov_b64 v[186:187], 0
    v_mov_b64 v[188:189], 0
    v_mov_b64 v[190:191], 0
    v_mov_b64 v[192:193], 0
    v_mov_b64 v[194:195], 0
    v_mov_b64 v[196:197], 0
    v_mov_b64 v[198:199], 0
    v_mov_b64 v[200:201], 0
    v_mov_b64 v[202:203], 0
    v_mov_b64 v[204:205], 0
    v_mov_b64 v[206:207], 0
    v_mov_b64 v[208:209], 0
    v_mov_b64 v[210:211], 0
    v_mov_b64 v[212:213], 0
    v_mov_b64 v[214:215], 0
    v_mov_b64 v[216:217], 0
    v_mov_b64 v[218:219], 0
    v_mov_b64 v[220:221], 0
    v_mov_b64 v[222:223], 0
    v_mov_b64 v[224:225], 0
    v_mov_b64 v[226:227], 0
    v_mov_b64 v[228:229], 0
    v_mov_b64 v[230:231], 0
    v_mov_b64 v[232:233], 0
    v_mov_b64 v[234:235], 0
    v_mov_b64 v[236:237], 0
    v_mov_b64 v[238:239], 0
    v_mov_b64 v[240:241], 0
    v_mov_b64 v[242:243], 0
    v_mov_b64 v[244:245], 0
    v_mov_b64 v[246:247], 0
    v_mov_b64 v[248:249], 0
    v_mov_b64 v[250:251], 0
    v_mov_b64 v[252:253], 0
    v_mov_b64 v[254:255], 0
    s_mov_b32 s33, 12288
    s_mov_b32 s34, 8192
    v_add_u32 v22, s33, v12
    v_add_u32 v23, s34, v13
    v_add_u32 v24, s34, v14
    s_mov_b32 s30, 0
    s_barrier
    ds_read_b64_tr_b16 v[32:33], v12 offset:0
    ds_read_b64_tr_b16 v[34:35], v12 offset:768
    ds_read_b64_tr_b16 v[36:37], v12 offset:256
    ds_read_b64_tr_b16 v[38:39], v12 offset:1024
    ds_read_b64_tr_b16 v[40:41], v12 offset:512
    ds_read_b64_tr_b16 v[42:43], v12 offset:1280
    ds_read_b64_tr_b16 v[44:45], v12 offset:6144
    ds_read_b64_tr_b16 v[46:47], v12 offset:6912
    ds_read_b64_tr_b16 v[48:49], v12 offset:6400
    ds_read_b64_tr_b16 v[50:51], v12 offset:7168
    ds_read_b64_tr_b16 v[52:53], v12 offset:6656
    ds_read_b64_tr_b16 v[54:55], v12 offset:7424
    s_barrier
    ds_read_b64_tr_b16 v[56:57], v13 offset:0
    ds_read_b64_tr_b16 v[58:59], v13 offset:1024
    ds_read_b64_tr_b16 v[60:61], v14 offset:0
    ds_read_b64_tr_b16 v[62:63], v14 offset:1024
    ds_read_b64_tr_b16 v[64:65], v13 offset:256
    ds_read_b64_tr_b16 v[66:67], v13 offset:1280
    ds_read_b64_tr_b16 v[68:69], v14 offset:256
    ds_read_b64_tr_b16 v[70:71], v14 offset:1280
LF_loop:
    s_waitcnt lgkmcnt(0)
    s_barrier
    v_mfma_f32_16x16x32_bf16 v[160:163], v[32:35], v[56:59], v[160:163]
    ds_read_b64_tr_b16 v[72:73], v22 offset:0
    ds_read_b64_tr_b16 v[74:75], v22 offset:768
    v_mfma_f32_16x16x32_bf16 v[164:167], v[32:35], v[60:63], v[164:167]
    ds_read_b64_tr_b16 v[96:97], v23 offset:0
    v_mfma_f32_16x16x32_bf16 v[168:171], v[32:35], v[64:67], v[168:171]
    ds_read_b64_tr_b16 v[98:99], v23 offset:1024
    s_add_u32 s33, s33, 12288
    v_mfma_f32_16x16x32_bf16 v[172:175], v[32:35], v[68:71], v[172:175]
    ds_read_b64_tr_b16 v[100:101], v24 offset:0
    v_mfma_f32_16x16x32_bf16 v[188:191], v[36:39], v[68:71], v[188:191]
    ds_read_b64_tr_b16 v[102:103], v24 offset:1024
    s_cmp_eq_u32 s33, 110592
    v_mfma_f32_16x16x32_bf16 v[184:187], v[36:39], v[64:67], v[184:187]
    ds_read_b64_tr_b16 v[104:105], v23 offset:256
    v_mfma_f32_16x16x32_bf16 v[180:183], v[36:39], v[60:63], v[180:183]
    ds_read_b64_tr_b16 v[106:107], v23 offset:1280
    s_cselect_b32 s33, 0, s33
    v_mfma_f32_16x16x32_bf16 v[176:179], v[36:39], v[56:59], v[176:179]
    ds_read_b64_tr_b16 v[108:109], v24 offset:256
    v_mfma_f32_16x16x32_bf16 v[192:195], v[40:43], v[56:59], v[192:195]
    ds_read_b64_tr_b16 v[110:111], v24 offset:1280
    s_add_u32 s34, s34, 8192
    v_mfma_f32_16x16x32_bf16 v[196:199], v[40:43], v[60:63], v[196:199]
    ds_read_b64_tr_b16 v[76:77], v22 offset:256
    v_mfma_f32_16x16x32_bf16 v[200:203], v[40:43], v[64:67], v[200:203]
    ds_read_b64_tr_b16 v[78:79], v22 offset:1024
    s_cmp_eq_u32 s34, 49152
    v_mfma_f32_16x16x32_bf16 v[204:207], v[40:43], v[68:71], v[204:207]
    ds_read_b64_tr_b16 v[80:81], v22 offset:512
    v_mfma_f32_16x16x32_bf16 v[220:223], v[44:47], v[68:71], v[220:223]
    ds_read_b64_tr_b16 v[82:83], v22 offset:1280
    s_cselect_b32 s34, 0, s34
    v_mfma_f32_16x16x32_bf16 v[216:219], v[44:47], v[64:67], v[216:219]
    ds_read_b64_tr_b16 v[84:85], v22 offset:6144
    v_mfma_f32_16x16x32_bf16 v[212:215], v[44:47], v[60:63], v[212:215]
    ds_read_b64_tr_b16 v[86:87], v22 offset:6912
    v_mfma_f32_16x16x32_bf16 v[208:211], v[44:47], v[56:59], v[208:211]
    ds_read_b64_tr_b16 v[88:89], v22 offset:6400
    v_mfma_f32_16x16x32_bf16 v[224:227], v[48:51], v[56:59], v[224:227]
    ds_read_b64_tr_b16 v[90:91], v22 offset:7168
    v_mfma_f32_16x16x32_bf16 v[228:231], v[48:51], v[60:63], v[228:231]
    ds_read_b64_tr_b16 v[92:93], v22 offset:6656
    v_mfma_f32_16x16x32_bf16 v[232:235], v[48:51], v[64:67], v[232:235]
    ds_read_b64_tr_b16 v[94:95], v22 offset:7424
    v_mfma_f32_16x16x32_bf16 v[236:239], v[48:51], v[68:71], v[236:239]
    v_add_u32 v27, s33, v12
    v_mfma_f32_16x16x32_bf16 v[252:255], v[52:55], v[68:71], v[252:255]
    v_add_u32 v28, s34, v13
    v_mfma_f32_16x16x32_bf16 v[248:251], v[52:55], v[64:67], v[248:251]
    v_add_u32 v29, s34, v14
    v_mfma_f32_16x16x32_bf16 v[244:247], v[52:55], v[60:63], v[244:247]
    v_mfma_f32_16x16x32_bf16 v[240:243], v[52:55], v[56:59], v[240:243]
    s_waitcnt lgkmcnt(0)
    v_mfma_f32_16x16x32_bf16 v[160:163], v[72:75], v[96:99], v[160:163]
    ds_read_b64_tr_b16 v[32:33], v27 offset:0
    ds_read_b64_tr_b16 v[34:35], v27 offset:768
    v_mfma_f32_16x16x32_bf16 v[164:167], v[72:75], v[100:103], v[164:167]
    ds_read_b64_tr_b16 v[56:57], v28 offset:0
    v_mfma_f32_16x16x32_bf16 v[168:171], v[72:75], v[104:107], v[168:171]
    ds_read_b64_tr_b16 v[58:59], v28 offset:1024
    s_add_u32 s33, s33, 12288
    v_mfma_f32_16x16x32_bf16 v[172:175], v[72:75], v[108:111], v[172:175]
    ds_read_b64_tr_b16 v[60:61], v29 offset:0
    v_mfma_f32_16x16x32_bf16 v[188:191], v[76:79], v[108:111], v[188:191]
    ds_read_b64_tr_b16 v[62:63], v29 offset:1024
    s_cmp_eq_u32 s33, 110592
    v_mfma_f32_16x16x32_bf16 v[184:187], v[76:79], v[104:107], v[184:187]
    ds_read_b64_tr_b16 v[64:65], v28 offset:256
    v_mfma_f32_16x16x32_bf16 v[180:183], v[76:79], v[100:103], v[180:183]
    ds_read_b64_tr_b16 v[66:67], v28 offset:1280
    s_cselect_b32 s33, 0, s33
    v_mfma_f32_16x16x32_bf16 v[176:179], v[76:79], v[96:99], v[176:179]
    ds_read_b64_tr_b16 v[68:69], v29 offset:256
    v_mfma_f32_16x16x32_bf16 v[192:195], v[80:83], v[96:99], v[192:195]
    ds_read_b64_tr_b16 v[70:71], v29 offset:1280
    s_add_u32 s34, s34, 8192
    v_mfma_f32_16x16x32_bf16 v[196:199], v[80:83], v[100:103], v[196:199]
    ds_read_b64_tr_b16 v[36:37], v27 offset:256
    v_mfma_f32_16x16x32_bf16 v[200:203], v[80:83], v[104:107], v[200:203]
    ds_read_b64_tr_b16 v[38:39], v27 offset:1024
    s_cmp_eq_u32 s34, 49152
    v_mfma_f32_16x16x32_bf16 v[204:207], v[80:83], v[108:111], v[204:207]
    ds_read_b64_tr_b16 v[40:41], v27 offset:512
    v_mfma_f32_16x16x32_bf16 v[220:223], v[84:87], v[108:111], v[220:223]
    ds_read_b64_tr_b16 v[42:43], v27 offset:1280
    s_cselect_b32 s34, 0, s34
    v_mfma_f32_16x16x32_bf16 v[216:219], v[84:87], v[104:107], v[216:219]
    ds_read_b64_tr_b16 v[44:45], v27 offset:6144
    v_mfma_f32_16x16x32_bf16 v[212:215], v[84:87], v[100:103], v[212:215]
    ds_read_b64_tr_b16 v[46:47], v27 offset:6912
    v_mfma_f32_16x16x32_bf16 v[208:211], v[84:87], v[96:99], v[208:211]
    ds_read_b64_tr_b16 v[48:49], v27 offset:6400
    v_mfma_f32_16x16x32_bf16 v[224:227], v[88:91], v[96:99], v[224:227]
    ds_read_b64_tr_b16 v[50:51], v27 offset:7168
    v_mfma_f32_16x16x32_bf16 v[228:231], v[88:91], v[100:103], v[228:231]
    ds_read_b64_tr_b16 v[52:53], v27 offset:6656
    v_mfma_f32_16x16x32_bf16 v[232:235], v[88:91], v[104:107], v[232:235]
    ds_read_b64_tr_b16 v[54:55], v27 offset:7424
    v_mfma_f32_16x16x32_bf16 v[236:239], v[88:91], v[108:111], v[236:239]
    v_add_u32 v22, s33, v12
    v_mfma_f32_16x16x32_bf16 v[252:255], v[92:95], v[108:111], v[252:255]
    v_add_u32 v23, s34, v13
    v_mfma_f32_16x16x32_bf16 v[248:251], v[92:95], v[104:107], v[248:251]
    v_add_u32 v24, s34, v14
    v_mfma_f32_16x16x32_bf16 v[244:247], v[92:95], v[100:103], v[244:247]
    s_add_u32 s30, s30, 1
    v_mfma_f32_16x16x32_bf16 v[240:243], v[92:95], v[96:99], v[240:243]
    s_cmp_lt_u32 s30, 10
    s_cbranch_scc1 LF_loop
    s_barrier
    ds_read_b128 v[112:115], v19 offset:0
    ds_read_b128 v[116:119], v19 offset:256
    ds_read_b128 v[120:123], v19 offset:512
    ds_read_b128 v[124:127], v19 offset:768
    ds_read_b128 v[128:131], v17 offset:0
    ds_read_b128 v[132:135], v17 offset:128
    ds_read_b128 v[136:139], v17 offset:256
    ds_read_b128 v[140:143], v17 offset:384
    ds_read_b128 v[144:147], v17 offset:512
    ds_read_b128 v[148:151], v17 offset:640
    s_waitcnt lgkmcnt(0)
    v_pk_fma_f32 v[160:161], v[128:129], v[112:113], v[160:161] op_sel:[0,0,0] op_sel_hi:[1,0,1] neg_lo:[1,0,0] neg_hi:[1,0,0]
    v_pk_fma_f32 v[162:163], v[130:131], v[112:113], v[162:163] op_sel:[0,0,0] op_sel_hi:[1,0,1] neg_lo:[1,0,0] neg_hi:[1,0,0]
    v_pk_fma_f32 v[164:165], v[128:129], v[116:117], v[164:165] op_sel:[0,0,0] op_sel_hi:[1,0,1] neg_lo:[1,0,0] neg_hi:[1,0,0]
    v_pk_fma_f32 v[166:167], v[130:131], v[116:117], v[166:167] op_sel:[0,0,0] op_sel_hi:[1,0,1] neg_lo:[1,0,0] neg_hi:[1,0,0]
    v_pk_fma_f32 v[168:169], v[128:129], v[120:121], v[168:169] op_sel:[0,0,0] op_sel_hi:[1,0,1] neg_lo:[1,0,0] neg_hi:[1,0,0]
    v_pk_fma_f32 v[170:171], v[130:131], v[120:121], v[170:171] op_sel:[0,0,0] op_sel_hi:[1,0,1] neg_lo:[1,0,0] neg_hi:[1,0,0]
    v_pk_fma_f32 v[172:173], v[128:129], v[124:125], v[172:173] op_sel:[0,0,0] op_sel_hi:[1,0,1] neg_lo:[1,0,0] neg_hi:[1,0,0]
    v_pk_fma_f32 v[174:175], v[130:131], v[124:125], v[174:175] op_sel:[0,0,0] op_sel_hi:[1,0,1] neg_lo:[1,0,0] neg_hi:[1,0,0]
    v_pk_mul_f32 v[32:33], v[160:161], v[112:113] op_sel:[0,1] op_sel_hi:[1,1]
    v_pk_mul_f32 v[34:35], v[162:163], v[112:113] op_sel:[0,1] op_sel_hi:[1,1]
    v_pk_mul_f32 v[36:37], v[164:165], v[116:117] op_sel:[0,1] op_sel_hi:[1,1]
    v_pk_mul_f32 v[38:39], v[166:167], v[116:117] op_sel:[0,1] op_sel_hi:[1,1]
    v_pk_mul_f32 v[40:41], v[168:169], v[120:121] op_sel:[0,1] op_sel_hi:[1,1]
    v_pk_mul_f32 v[42:43], v[170:171], v[120:121] op_sel:[0,1] op_sel_hi:[1,1]
    v_pk_mul_f32 v[44:45], v[172:173], v[124:125] op_sel:[0,1] op_sel_hi:[1,1]
    v_pk_mul_f32 v[46:47], v[174:175], v[124:125] op_sel:[0,1] op_sel_hi:[1,1]
    v_exp_f32 v32, v32
    v_pk_fma_f32 v[208:209], v[140:141], v[112:113], v[208:209] op_sel:[0,0,0] op_sel_hi:[1,0,1] neg_lo:[1,0,0] neg_hi:[1,0,0]
    v_exp_f32 v33, v33
    v_exp_f32 v34, v34
    v_pk_fma_f32 v[210:211], v[142:143], v[112:113], v[210:211] op_sel:[0,0,0] op_sel_hi:[1,0,1] neg_lo:[1,0,0] neg_hi:[1,0,0]
    v_exp_f32 v35, v35
    v_exp_f32 v36, v36
    v_pk_fma_f32 v[212:213], v[140:141], v[116:117], v[212:213] op_sel:[0,0,0] op_sel_hi:[1,0,1] neg_lo:[1,0,0] neg_hi:[1,0,0]
    v_exp_f32 v37, v37
    v_exp_f32 v38, v38
    v_pk_fma_f32 v[214:215], v[142:143], v[116:117], v[214:215] op_sel:[0,0,0] op_sel_hi:[1,0,1] neg_lo:[1,0,0] neg_hi:[1,0,0]
    v_exp_f32 v39, v39
    v_exp_f32 v40, v40
    v_pk_fma_f32 v[216:217], v[140:141], v[120:121], v[216:217] op_sel:[0,0,0] op_sel_hi:[1,0,1] neg_lo:[1,0,0] neg_hi:[1,0,0]
    v_exp_f32 v41, v41
    v_exp_f32 v42, v42
    v_pk_fma_f32 v[218:219], v[142:143], v[120:121], v[218:219] op_sel:[0,0,0] op_sel_hi:[1,0,1] neg_lo:[1,0,0] neg_hi:[1,0,0]
    v_exp_f32 v43, v43
    v_exp_f32 v44, v44
    v_pk_fma_f32 v[220:221], v[140:141], v[124:125], v[220:221] op_sel:[0,0,0] op_sel_hi:[1,0,1] neg_lo:[1,0,0] neg_hi:[1,0,0]
    v_exp_f32 v45, v45
    v_exp_f32 v46, v46
    v_pk_fma_f32 v[222:223], v[142:143], v[124:125], v[222:223] op_sel:[0,0,0] op_sel_hi:[1,0,1] neg_lo:[1,0,0] neg_hi:[1,0,0]
    v_exp_f32 v47, v47
    v_pk_fma_f32 v[32:33], v[32:33], v[114:115], v[114:115] op_sel:[0,0,0] op_sel_hi:[1,0,0]
    v_pk_fma_f32 v[34:35], v[34:35], v[114:115], v[114:115] op_sel:[0,0,0] op_sel_hi:[1,0,0]
    v_pk_fma_f32 v[36:37], v[36:37], v[118:119], v[118:119] op_sel:[0,0,0] op_sel_hi:[1,0,0]
    v_pk_fma_f32 v[38:39], v[38:39], v[118:119], v[118:119] op_sel:[0,0,0] op_sel_hi:[1,0,0]
    v_pk_fma_f32 v[40:41], v[40:41], v[122:123], v[122:123] op_sel:[0,0,0] op_sel_hi:[1,0,0]
    v_pk_fma_f32 v[42:43], v[42:43], v[122:123], v[122:123] op_sel:[0,0,0] op_sel_hi:[1,0,0]
    v_pk_fma_f32 v[44:45], v[44:45], v[126:127], v[126:127] op_sel:[0,0,0] op_sel_hi:[1,0,0]
    v_pk_fma_f32 v[46:47], v[46:47], v[126:127], v[126:127] op_sel:[0,0,0] op_sel_hi:[1,0,0]
    v_rcp_f32 v32, v32
    v_pk_mul_f32 v[160:161], v[160:161], v[208:209]
    v_rcp_f32 v33, v33
    v_rcp_f32 v34, v34
    v_pk_mul_f32 v[162:163], v[162:163], v[210:211]
    v_rcp_f32 v35, v35
    v_rcp_f32 v36, v36
    v_pk_mul_f32 v[164:165], v[164:165], v[212:213]
    v_rcp_f32 v37, v37
    v_rcp_f32 v38, v38
    v_pk_mul_f32 v[166:167], v[166:167], v[214:215]
    v_rcp_f32 v39, v39
    v_rcp_f32 v40, v40
    v_pk_mul_f32 v[168:169], v[168:169], v[216:217]
    v_rcp_f32 v41, v41
    v_rcp_f32 v42, v42
    v_pk_mul_f32 v[170:171], v[170:171], v[218:219]
    v_rcp_f32 v43, v43
    v_rcp_f32 v44, v44
    v_pk_mul_f32 v[172:173], v[172:173], v[220:221]
    v_rcp_f32 v45, v45
    v_rcp_f32 v46, v46
    v_pk_mul_f32 v[174:175], v[174:175], v[222:223]
    v_rcp_f32 v47, v47
    v_pk_mul_f32 v[160:161], v[160:161], v[32:33]
    v_pk_mul_f32 v[162:163], v[162:163], v[34:35]
    v_pk_mul_f32 v[164:165], v[164:165], v[36:37]
    v_pk_mul_f32 v[166:167], v[166:167], v[38:39]
    v_pk_mul_f32 v[168:169], v[168:169], v[40:41]
    v_pk_mul_f32 v[170:171], v[170:171], v[42:43]
    v_pk_mul_f32 v[172:173], v[172:173], v[44:45]
    v_pk_mul_f32 v[174:175], v[174:175], v[46:47]
    v_cvt_pk_bf16_f32 v48, v160, v161
    v_cvt_pk_bf16_f32 v49, v162, v163
    v_cvt_pk_bf16_f32 v50, v164, v165
    v_cvt_pk_bf16_f32 v51, v166, v167
    v_cvt_pk_bf16_f32 v52, v168, v169
    v_cvt_pk_bf16_f32 v53, v170, v171
    v_cvt_pk_bf16_f32 v54, v172, v173
    v_cvt_pk_bf16_f32 v55, v174, v175
    v_permlane16_swap_b32 v48, v50
    v_permlane16_swap_b32 v49, v51
    v_permlane16_swap_b32 v52, v54
    v_permlane16_swap_b32 v53, v55
    global_store_dwordx4 v18, v[48:51], s[42:43] offset:0 sc1
    global_store_dwordx4 v20, v[52:55], s[42:43] offset:0 sc1
    v_pk_fma_f32 v[176:177], v[132:133], v[112:113], v[176:177] op_sel:[0,0,0] op_sel_hi:[1,0,1] neg_lo:[1,0,0] neg_hi:[1,0,0]
    v_pk_fma_f32 v[178:179], v[134:135], v[112:113], v[178:179] op_sel:[0,0,0] op_sel_hi:[1,0,1] neg_lo:[1,0,0] neg_hi:[1,0,0]
    v_pk_fma_f32 v[180:181], v[132:133], v[116:117], v[180:181] op_sel:[0,0,0] op_sel_hi:[1,0,1] neg_lo:[1,0,0] neg_hi:[1,0,0]
    v_pk_fma_f32 v[182:183], v[134:135], v[116:117], v[182:183] op_sel:[0,0,0] op_sel_hi:[1,0,1] neg_lo:[1,0,0] neg_hi:[1,0,0]
    v_pk_fma_f32 v[184:185], v[132:133], v[120:121], v[184:185] op_sel:[0,0,0] op_sel_hi:[1,0,1] neg_lo:[1,0,0] neg_hi:[1,0,0]
    v_pk_fma_f32 v[186:187], v[134:135], v[120:121], v[186:187] op_sel:[0,0,0] op_sel_hi:[1,0,1] neg_lo:[1,0,0] neg_hi:[1,0,0]
    v_pk_fma_f32 v[188:189], v[132:133], v[124:125], v[188:189] op_sel:[0,0,0] op_sel_hi:[1,0,1] neg_lo:[1,0,0] neg_hi:[1,0,0]
    v_pk_fma_f32 v[190:191], v[134:135], v[124:125], v[190:191] op_sel:[0,0,0] op_sel_hi:[1,0,1] neg_lo:[1,0,0] neg_hi:[1,0,0]
    v_pk_mul_f32 v[32:33], v[176:177], v[112:113] op_sel:[0,1] op_sel_hi:[1,1]
    v_pk_mul_f32 v[34:35], v[178:179], v[112:113] op_sel:[0,1] op_sel_hi:[1,1]
    v_pk_mul_f32 v[36:37], v[180:181], v[116:117] op_sel:[0,1] op_sel_hi:[1,1]
    v_pk_mul_f32 v[38:39], v[182:183], v[116:117] op_sel:[0,1] op_sel_hi:[1,1]
    v_pk_mul_f32 v[40:41], v[184:185], v[120:121] op_sel:[0,1] op_sel_hi:[1,1]
    v_pk_mul_f32 v[42:43], v[186:187], v[120:121] op_sel:[0,1] op_sel_hi:[1,1]
    v_pk_mul_f32 v[44:45], v[188:189], v[124:125] op_sel:[0,1] op_sel_hi:[1,1]
    v_pk_mul_f32 v[46:47], v[190:191], v[124:125] op_sel:[0,1] op_sel_hi:[1,1]
    v_exp_f32 v32, v32
    v_pk_fma_f32 v[224:225], v[144:145], v[112:113], v[224:225] op_sel:[0,0,0] op_sel_hi:[1,0,1] neg_lo:[1,0,0] neg_hi:[1,0,0]
    v_exp_f32 v33, v33
    v_exp_f32 v34, v34
    v_pk_fma_f32 v[226:227], v[146:147], v[112:113], v[226:227] op_sel:[0,0,0] op_sel_hi:[1,0,1] neg_lo:[1,0,0] neg_hi:[1,0,0]
    v_exp_f32 v35, v35
    v_exp_f32 v36, v36
    v_pk_fma_f32 v[228:229], v[144:145], v[116:117], v[228:229] op_sel:[0,0,0] op_sel_hi:[1,0,1] neg_lo:[1,0,0] neg_hi:[1,0,0]
    v_exp_f32 v37, v37
    v_exp_f32 v38, v38
    v_pk_fma_f32 v[230:231], v[146:147], v[116:117], v[230:231] op_sel:[0,0,0] op_sel_hi:[1,0,1] neg_lo:[1,0,0] neg_hi:[1,0,0]
    v_exp_f32 v39, v39
    v_exp_f32 v40, v40
    v_pk_fma_f32 v[232:233], v[144:145], v[120:121], v[232:233] op_sel:[0,0,0] op_sel_hi:[1,0,1] neg_lo:[1,0,0] neg_hi:[1,0,0]
    v_exp_f32 v41, v41
    v_exp_f32 v42, v42
    v_pk_fma_f32 v[234:235], v[146:147], v[120:121], v[234:235] op_sel:[0,0,0] op_sel_hi:[1,0,1] neg_lo:[1,0,0] neg_hi:[1,0,0]
    v_exp_f32 v43, v43
    v_exp_f32 v44, v44
    v_pk_fma_f32 v[236:237], v[144:145], v[124:125], v[236:237] op_sel:[0,0,0] op_sel_hi:[1,0,1] neg_lo:[1,0,0] neg_hi:[1,0,0]
    v_exp_f32 v45, v45
    v_exp_f32 v46, v46
    v_pk_fma_f32 v[238:239], v[146:147], v[124:125], v[238:239] op_sel:[0,0,0] op_sel_hi:[1,0,1] neg_lo:[1,0,0] neg_hi:[1,0,0]
    v_exp_f32 v47, v47
    v_pk_fma_f32 v[32:33], v[32:33], v[114:115], v[114:115] op_sel:[0,0,0] op_sel_hi:[1,0,0]
    v_pk_fma_f32 v[34:35], v[34:35], v[114:115], v[114:115] op_sel:[0,0,0] op_sel_hi:[1,0,0]
    v_pk_fma_f32 v[36:37], v[36:37], v[118:119], v[118:119] op_sel:[0,0,0] op_sel_hi:[1,0,0]
    v_pk_fma_f32 v[38:39], v[38:39], v[118:119], v[118:119] op_sel:[0,0,0] op_sel_hi:[1,0,0]
    v_pk_fma_f32 v[40:41], v[40:41], v[122:123], v[122:123] op_sel:[0,0,0] op_sel_hi:[1,0,0]
    v_pk_fma_f32 v[42:43], v[42:43], v[122:123], v[122:123] op_sel:[0,0,0] op_sel_hi:[1,0,0]
    v_pk_fma_f32 v[44:45], v[44:45], v[126:127], v[126:127] op_sel:[0,0,0] op_sel_hi:[1,0,0]
    v_pk_fma_f32 v[46:47], v[46:47], v[126:127], v[126:127] op_sel:[0,0,0] op_sel_hi:[1,0,0]
    v_rcp_f32 v32, v32
    v_pk_mul_f32 v[176:177], v[176:177], v[224:225]
    v_rcp_f32 v33, v33
    v_rcp_f32 v34, v34
    v_pk_mul_f32 v[178:179], v[178:179], v[226:227]
    v_rcp_f32 v35, v35
    v_rcp_f32 v36, v36
    v_pk_mul_f32 v[180:181], v[180:181], v[228:229]
    v_rcp_f32 v37, v37
    v_rcp_f32 v38, v38
    v_pk_mul_f32 v[182:183], v[182:183], v[230:231]
    v_rcp_f32 v39, v39
    v_rcp_f32 v40, v40
    v_pk_mul_f32 v[184:185], v[184:185], v[232:233]
    v_rcp_f32 v41, v41
    v_rcp_f32 v42, v42
    v_pk_mul_f32 v[186:187], v[186:187], v[234:235]
    v_rcp_f32 v43, v43
    v_rcp_f32 v44, v44
    v_pk_mul_f32 v[188:189], v[188:189], v[236:237]
    v_rcp_f32 v45, v45
    v_rcp_f32 v46, v46
    v_pk_mul_f32 v[190:191], v[190:191], v[238:239]
    v_rcp_f32 v47, v47
    v_pk_mul_f32 v[176:177], v[176:177], v[32:33]
    v_pk_mul_f32 v[178:179], v[178:179], v[34:35]
    v_pk_mul_f32 v[180:181], v[180:181], v[36:37]
    v_pk_mul_f32 v[182:183], v[182:183], v[38:39]
    v_pk_mul_f32 v[184:185], v[184:185], v[40:41]
    v_pk_mul_f32 v[186:187], v[186:187], v[42:43]
    v_pk_mul_f32 v[188:189], v[188:189], v[44:45]
    v_pk_mul_f32 v[190:191], v[190:191], v[46:47]
    v_cvt_pk_bf16_f32 v56, v176, v177
    v_cvt_pk_bf16_f32 v57, v178, v179
    v_cvt_pk_bf16_f32 v58, v180, v181
    v_cvt_pk_bf16_f32 v59, v182, v183
    v_cvt_pk_bf16_f32 v60, v184, v185
    v_cvt_pk_bf16_f32 v61, v186, v187
    v_cvt_pk_bf16_f32 v62, v188, v189
    v_cvt_pk_bf16_f32 v63, v190, v191
    v_permlane16_swap_b32 v56, v58
    v_permlane16_swap_b32 v57, v59
    v_permlane16_swap_b32 v60, v62
    v_permlane16_swap_b32 v61, v63
    global_store_dwordx4 v18, v[56:59], s[42:43] offset:1024 sc1
    global_store_dwordx4 v20, v[60:63], s[42:43] offset:1024 sc1
    v_pk_fma_f32 v[192:193], v[136:137], v[112:113], v[192:193] op_sel:[0,0,0] op_sel_hi:[1,0,1] neg_lo:[1,0,0] neg_hi:[1,0,0]
    v_pk_fma_f32 v[194:195], v[138:139], v[112:113], v[194:195] op_sel:[0,0,0] op_sel_hi:[1,0,1] neg_lo:[1,0,0] neg_hi:[1,0,0]
    v_pk_fma_f32 v[196:197], v[136:137], v[116:117], v[196:197] op_sel:[0,0,0] op_sel_hi:[1,0,1] neg_lo:[1,0,0] neg_hi:[1,0,0]
    v_pk_fma_f32 v[198:199], v[138:139], v[116:117], v[198:199] op_sel:[0,0,0] op_sel_hi:[1,0,1] neg_lo:[1,0,0] neg_hi:[1,0,0]
    v_pk_fma_f32 v[200:201], v[136:137], v[120:121], v[200:201] op_sel:[0,0,0] op_sel_hi:[1,0,1] neg_lo:[1,0,0] neg_hi:[1,0,0]
    v_pk_fma_f32 v[202:203], v[138:139], v[120:121], v[202:203] op_sel:[0,0,0] op_sel_hi:[1,0,1] neg_lo:[1,0,0] neg_hi:[1,0,0]
    v_pk_fma_f32 v[204:205], v[136:137], v[124:125], v[204:205] op_sel:[0,0,0] op_sel_hi:[1,0,1] neg_lo:[1,0,0] neg_hi:[1,0,0]
    v_pk_fma_f32 v[206:207], v[138:139], v[124:125], v[206:207] op_sel:[0,0,0] op_sel_hi:[1,0,1] neg_lo:[1,0,0] neg_hi:[1,0,0]
    v_pk_mul_f32 v[32:33], v[192:193], v[112:113] op_sel:[0,1] op_sel_hi:[1,1]
    v_pk_mul_f32 v[34:35], v[194:195], v[112:113] op_sel:[0,1] op_sel_hi:[1,1]
    v_pk_mul_f32 v[36:37], v[196:197], v[116:117] op_sel:[0,1] op_sel_hi:[1,1]
    v_pk_mul_f32 v[38:39], v[198:199], v[116:117] op_sel:[0,1] op_sel_hi:[1,1]
    v_pk_mul_f32 v[40:41], v[200:201], v[120:121] op_sel:[0,1] op_sel_hi:[1,1]
    v_pk_mul_f32 v[42:43], v[202:203], v[120:121] op_sel:[0,1] op_sel_hi:[1,1]
    v_pk_mul_f32 v[44:45], v[204:205], v[124:125] op_sel:[0,1] op_sel_hi:[1,1]
    v_pk_mul_f32 v[46:47], v[206:207], v[124:125] op_sel:[0,1] op_sel_hi:[1,1]
    v_exp_f32 v32, v32
    v_pk_fma_f32 v[240:241], v[148:149], v[112:113], v[240:241] op_sel:[0,0,0] op_sel_hi:[1,0,1] neg_lo:[1,0,0] neg_hi:[1,0,0]
    v_exp_f32 v33, v33
    v_exp_f32 v34, v34
    v_pk_fma_f32 v[242:243], v[150:151], v[112:113], v[242:243] op_sel:[0,0,0] op_sel_hi:[1,0,1] neg_lo:[1,0,0] neg_hi:[1,0,0]
    v_exp_f32 v35, v35
    v_exp_f32 v36, v36
    v_pk_fma_f32 v[244:245], v[148:149], v[116:117], v[244:245] op_sel:[0,0,0] op_sel_hi:[1,0,1] neg_lo:[1,0,0] neg_hi:[1,0,0]
    v_exp_f32 v37, v37
    v_exp_f32 v38, v38
    v_pk_fma_f32 v[246:247], v[150:151], v[116:117], v[246:247] op_sel:[0,0,0] op_sel_hi:[1,0,1] neg_lo:[1,0,0] neg_hi:[1,0,0]
    v_exp_f32 v39, v39
    v_exp_f32 v40, v40
    v_pk_fma_f32 v[248:249], v[148:149], v[120:121], v[248:249] op_sel:[0,0,0] op_sel_hi:[1,0,1] neg_lo:[1,0,0] neg_hi:[1,0,0]
    v_exp_f32 v41, v41
    v_exp_f32 v42, v42
    v_pk_fma_f32 v[250:251], v[150:151], v[120:121], v[250:251] op_sel:[0,0,0] op_sel_hi:[1,0,1] neg_lo:[1,0,0] neg_hi:[1,0,0]
    v_exp_f32 v43, v43
    v_exp_f32 v44, v44
    v_pk_fma_f32 v[252:253], v[148:149], v[124:125], v[252:253] op_sel:[0,0,0] op_sel_hi:[1,0,1] neg_lo:[1,0,0] neg_hi:[1,0,0]
    v_exp_f32 v45, v45
    v_exp_f32 v46, v46
    v_pk_fma_f32 v[254:255], v[150:151], v[124:125], v[254:255] op_sel:[0,0,0] op_sel_hi:[1,0,1] neg_lo:[1,0,0] neg_hi:[1,0,0]
    v_exp_f32 v47, v47
    v_pk_fma_f32 v[32:33], v[32:33], v[114:115], v[114:115] op_sel:[0,0,0] op_sel_hi:[1,0,0]
    v_pk_fma_f32 v[34:35], v[34:35], v[114:115], v[114:115] op_sel:[0,0,0] op_sel_hi:[1,0,0]
    v_pk_fma_f32 v[36:37], v[36:37], v[118:119], v[118:119] op_sel:[0,0,0] op_sel_hi:[1,0,0]
    v_pk_fma_f32 v[38:39], v[38:39], v[118:119], v[118:119] op_sel:[0,0,0] op_sel_hi:[1,0,0]
    v_pk_fma_f32 v[40:41], v[40:41], v[122:123], v[122:123] op_sel:[0,0,0] op_sel_hi:[1,0,0]
    v_pk_fma_f32 v[42:43], v[42:43], v[122:123], v[122:123] op_sel:[0,0,0] op_sel_hi:[1,0,0]
    v_pk_fma_f32 v[44:45], v[44:45], v[126:127], v[126:127] op_sel:[0,0,0] op_sel_hi:[1,0,0]
    v_pk_fma_f32 v[46:47], v[46:47], v[126:127], v[126:127] op_sel:[0,0,0] op_sel_hi:[1,0,0]
    v_rcp_f32 v32, v32
    v_pk_mul_f32 v[192:193], v[192:193], v[240:241]
    v_rcp_f32 v33, v33
    v_rcp_f32 v34, v34
    v_pk_mul_f32 v[194:195], v[194:195], v[242:243]
    v_rcp_f32 v35, v35
    v_rcp_f32 v36, v36
    v_pk_mul_f32 v[196:197], v[196:197], v[244:245]
    v_rcp_f32 v37, v37
    v_rcp_f32 v38, v38
    v_pk_mul_f32 v[198:199], v[198:199], v[246:247]
    v_rcp_f32 v39, v39
    v_rcp_f32 v40, v40
    v_pk_mul_f32 v[200:201], v[200:201], v[248:249]
    v_rcp_f32 v41, v41
    v_rcp_f32 v42, v42
    v_pk_mul_f32 v[202:203], v[202:203], v[250:251]
    v_rcp_f32 v43, v43
    v_rcp_f32 v44, v44
    v_pk_mul_f32 v[204:205], v[204:205], v[252:253]
    v_rcp_f32 v45, v45
    v_rcp_f32 v46, v46
    v_pk_mul_f32 v[206:207], v[206:207], v[254:255]
    v_rcp_f32 v47, v47
    v_pk_mul_f32 v[192:193], v[192:193], v[32:33]
    v_pk_mul_f32 v[194:195], v[194:195], v[34:35]
    v_pk_mul_f32 v[196:197], v[196:197], v[36:37]
    v_pk_mul_f32 v[198:199], v[198:199], v[38:39]
    v_pk_mul_f32 v[200:201], v[200:201], v[40:41]
    v_pk_mul_f32 v[202:203], v[202:203], v[42:43]
    v_pk_mul_f32 v[204:205], v[204:205], v[44:45]
    v_pk_mul_f32 v[206:207], v[206:207], v[46:47]
    v_cvt_pk_bf16_f32 v48, v192, v193
    v_cvt_pk_bf16_f32 v49, v194, v195
    v_cvt_pk_bf16_f32 v50, v196, v197
    v_cvt_pk_bf16_f32 v51, v198, v199
    v_cvt_pk_bf16_f32 v52, v200, v201
    v_cvt_pk_bf16_f32 v53, v202, v203
    v_cvt_pk_bf16_f32 v54, v204, v205
    v_cvt_pk_bf16_f32 v55, v206, v207
    v_permlane16_swap_b32 v48, v50
    v_permlane16_swap_b32 v49, v51
    v_permlane16_swap_b32 v52, v54
    v_permlane16_swap_b32 v53, v55
    global_store_dwordx4 v18, v[48:51], s[42:43] offset:2048 sc1
    global_store_dwordx4 v20, v[52:55], s[42:43] offset:2048 sc1
    s_and_b32 s6, s2, 1
    s_lshl_b32 s6, s6, 2
    s_bfe_u32 s7, s2, 0x20003
    s_add_u32 s6, s6, s7
    s_bfe_u32 s7, s2, 0x20001
    s_lshl_b32 s7, s7, 3
    s_lshr_b32 s5, s2, 5
    s_add_u32 s7, s7, s5
    v_lshlrev_b32 v10, 4, v1
    s_and_b32 s8, s3, 1
    s_lshr_b32 s9, s3, 1
    s_lshl_b32 s21, s7, 2
    s_lshl_b32 s10, s9, 1
    s_add_u32 s21, s21, s10
    s_mul_i32 s21, s21, 48
    s_add_u32 s23, s21, s8
    s_mul_i32 s10, s8, 3
    s_add_u32 s21, s21, s10
    s_lshl_b32 s21, s21, 10
    s_add_u32 s21, s21, 4194304
    s_add_u32 s22, s21, 49152
    s_lshl_b32 s23, s23, 10
    s_add_u32 s23, s23, 4195328
    s_add_u32 s24, s23, 49152
    s_mov_b32 s48, s42
    s_mov_b32 s49, s43
    s_mov_b32 s50, 10485760
    s_mov_b32 s51, 0x20000
    s_mul_i32 s10, s3, 5120
    s_add_u32 s10, s10, 122880
    v_add_u32 v14, s10, v10
    s_xor_b32 s10, s3, 1
    s_mul_i32 s10, s10, 5120
    s_add_u32 s10, s10, 122880
    v_add_u32 v15, s10, v10
    s_mul_i32 s10, s8, 5120
    v_add_u32 v4, s10, v10
    v_add_u32 v5, 61440, v4
    v_add_u32 v6, 122880, v4
    v_lshlrev_b32 v22, 9, v9
    v_lshl_add_u32 v22, v8, 3, v22
    s_lshl_b32 s10, s3, 7
    s_add_u32 s10, s10, 143360
    v_add_u32 v2, s10, v22
    s_lshl_b32 s10, s7, 6
    s_lshl_b32 s11, s3, 4
    s_add_u32 s10, s10, s11
    v_add_u32 v23, s10, v8
    v_mul_u32_u24 v23, 1280, v23
    v_lshl_add_u32 v23, v9, 3, v23
    s_mul_i32 s10, s6, 160
    v_add_u32 v3, s10, v23
    v_mov_b32 v9, 1
    s_lshr_b32 s10, s7, 1
    s_mul_i32 s10, s10, 4352
    s_add_u32 s10, s10, 10625024
    v_mov_b32_e64 v11, s10
    v_add_u32 v8, 208896, v11
    v_add_u32 v12, 69632, v21
    v_add_u32 v22, 208896, v21
    v_add_u32 v23, 278528, v21
    v_mov_b32 v24, 0
    s_mov_b64 exec, 1
    s_waitcnt vmcnt(4)
    ds_add_rtn_u32 v13, v7, v9
    s_waitcnt lgkmcnt(0)
    v_cmp_eq_u32 vcc, 3, v13
    s_cbranch_vccz LF_c1
    global_atomic_add v24, v21, v9, s[42:43] sc0 sc1
LF_c1:
    s_waitcnt vmcnt(0)
    ds_add_rtn_u32 v13, v7, v9 offset:4
    v_cmp_eq_u32 vcc, 15, v24
    s_cbranch_vccz LF_c2
    global_store_dword v12, v9, s[42:43] sc1
LF_c2:
    s_waitcnt lgkmcnt(0)
    v_cmp_eq_u32 vcc, 3, v13
    s_cbranch_vccz LF_c3
    global_atomic_add v13, v22, v9, s[42:43] sc0 sc1
    s_waitcnt vmcnt(0)
    v_cmp_eq_u32 vcc, 15, v13
    s_cbranch_vccz LF_c3
    global_store_dword v23, v9, s[42:43] sc1
LF_c3:
    s_mov_b64 exec, -1
    s_cmp_lg_u32 s3, 0
    s_cbranch_scc1 LF_p3d
LF_p3:
    global_load_dword v13, v11, s[42:43] sc1
    s_waitcnt vmcnt(0)
    v_cmp_ne_u32 vcc, 1, v13
    s_cbranch_vccz LF_p3d
    s_sleep 1
    s_branch LF_p3
LF_p3d:
    v_lshrrev_b32 v12, 4, v1
    v_and_b32 v13, 1, v12
    v_mul_u32_u24 v13, 24, v13
    v_add_u32 v13, v13, v3
    s_barrier
    buffer_load_dwordx4 v[96:99], v10, s[48:51], s21 offen sc1
    buffer_load_dwordx4 v[100:103], v10, s[48:51], s22 offen sc1
    s_add_u32 s21, s21, 6144
    s_add_u32 s22, s22, 6144
    buffer_load_dwordx4 v[104:107], v10, s[48:51], s21 offen sc1
    buffer_load_dwordx4 v[108:111], v10, s[48:51], s22 offen sc1
    s_add_u32 s21, s21, 6144
    s_add_u32 s22, s22, 6144
    buffer_load_dwordx4 v[112:115], v10, s[48:51], s21 offen sc1
    buffer_load_dwordx4 v[116:119], v10, s[48:51], s22 offen sc1
    s_add_u32 s21, s21, 6144
    s_add_u32 s22, s22, 6144
    buffer_load_dwordx4 v[120:123], v10, s[48:51], s21 offen sc1
    buffer_load_dwordx4 v[124:127], v10, s[48:51], s22 offen sc1
    s_add_u32 s21, s21, 6144
    s_add_u32 s22, s22, 6144
    buffer_load_dwordx4 v[128:131], v10, s[48:51], s21 offen sc1
    buffer_load_dwordx4 v[132:135], v10, s[48:51], s22 offen sc1
    s_add_u32 s21, s21, 6144
    s_add_u32 s22, s22, 6144
    buffer_load_dwordx4 v[136:139], v10, s[48:51], s21 offen sc1
    buffer_load_dwordx4 v[140:143], v10, s[48:51], s22 offen sc1
    s_add_u32 s21, s21, 6144
    s_add_u32 s22, s22, 6144
    buffer_load_dwordx4 v[144:147], v10, s[48:51], s21 offen sc1
    buffer_load_dwordx4 v[148:151], v10, s[48:51], s22 offen sc1
    s_add_u32 s21, s21, 6144
    s_add_u32 s22, s22, 6144
    buffer_load_dwordx4 v[152:155], v10, s[48:51], s21 offen sc1
    buffer_load_dwordx4 v[156:159], v10, s[48:51], s22 offen sc1
    s_add_u32 s21, s21, 6144
    s_add_u32 s22, s22, 6144
    ds_read_b128 v[56:59], v4 offset:0
    ds_read_b128 v[60:63], v4 offset:1024
    ds_read_b128 v[64:67], v4 offset:2048
    ds_read_b128 v[68:71], v4 offset:3072
    ds_read_b128 v[72:75], v4 offset:4096
    s_waitcnt vmcnt(14) lgkmcnt(0)
    v_mfma_f32_16x16x32_bf16 v[16:19], v[56:59], v[96:99], 0
    ds_read_b128 v[76:79], v4 offset:10240
    v_mfma_f32_16x16x32_bf16 v[36:39], v[56:59], v[100:103], 0
    ds_read_b128 v[80:83], v4 offset:11264
    v_mfma_f32_16x16x32_bf16 v[20:23], v[60:63], v[96:99], 0
    ds_read_b128 v[84:87], v4 offset:12288
    v_mfma_f32_16x16x32_bf16 v[40:43], v[60:63], v[100:103], 0
    ds_read_b128 v[88:91], v4 offset:13312
    v_mfma_f32_16x16x32_bf16 v[24:27], v[64:67], v[96:99], 0
    ds_read_b128 v[92:95], v4 offset:14336
    v_mfma_f32_16x16x32_bf16 v[44:47], v[64:67], v[100:103], 0
    v_mfma_f32_16x16x32_bf16 v[28:31], v[68:71], v[96:99], 0
    v_mfma_f32_16x16x32_bf16 v[48:51], v[68:71], v[100:103], 0
    v_mfma_f32_16x16x32_bf16 v[32:35], v[72:75], v[96:99], 0
    v_mfma_f32_16x16x32_bf16 v[52:55], v[72:75], v[100:103], 0
    s_waitcnt vmcnt(12) lgkmcnt(0)
    v_mfma_f32_16x16x32_bf16 v[16:19], v[76:79], v[104:107], v[16:19]
    global_load_dword v12, v8, s[42:43] sc1
    v_mfma_f32_16x16x32_bf16 v[36:39], v[76:79], v[108:111], v[36:39]
    ds_read_b128 v[56:59], v4 offset:20480
    v_mfma_f32_16x16x32_bf16 v[20:23], v[80:83], v[104:107], v[20:23]
    ds_read_b128 v[60:63], v4 offset:21504
    v_mfma_f32_16x16x32_bf16 v[40:43], v[80:83], v[108:111], v[40:43]
    ds_read_b128 v[64:67], v4 offset:22528
    v_mfma_f32_16x16x32_bf16 v[24:27], v[84:87], v[104:107], v[24:27]
    ds_read_b128 v[68:71], v4 offset:23552
    v_mfma_f32_16x16x32_bf16 v[44:47], v[84:87], v[108:111], v[44:47]
    ds_read_b128 v[72:75], v4 offset:24576
    v_mfma_f32_16x16x32_bf16 v[28:31], v[88:91], v[104:107], v[28:31]
    v_mfma_f32_16x16x32_bf16 v[48:51], v[88:91], v[108:111], v[48:51]
    v_mfma_f32_16x16x32_bf16 v[32:35], v[92:95], v[104:107], v[32:35]
    v_mfma_f32_16x16x32_bf16 v[52:55], v[92:95], v[108:111], v[52:55]
    s_waitcnt vmcnt(11) lgkmcnt(0)
    v_mfma_f32_16x16x32_bf16 v[16:19], v[56:59], v[112:115], v[16:19]
    ds_read_b128 v[76:79], v4 offset:30720
    v_mfma_f32_16x16x32_bf16 v[36:39], v[56:59], v[116:119], v[36:39]
    ds_read_b128 v[80:83], v4 offset:31744
    v_mfma_f32_16x16x32_bf16 v[20:23], v[60:63], v[112:115], v[20:23]
    ds_read_b128 v[84:87], v4 offset:32768
    v_mfma_f32_16x16x32_bf16 v[40:43], v[60:63], v[116:119], v[40:43]
    ds_read_b128 v[88:91], v4 offset:33792
    v_mfma_f32_16x16x32_bf16 v[24:27], v[64:67], v[112:115], v[24:27]
    ds_read_b128 v[92:95], v4 offset:34816
    v_mfma_f32_16x16x32_bf16 v[44:47], v[64:67], v[116:119], v[44:47]
    v_mfma_f32_16x16x32_bf16 v[28:31], v[68:71], v[112:115], v[28:31]
    v_mfma_f32_16x16x32_bf16 v[48:51], v[68:71], v[116:119], v[48:51]
    v_mfma_f32_16x16x32_bf16 v[32:35], v[72:75], v[112:115], v[32:35]
    v_mfma_f32_16x16x32_bf16 v[52:55], v[72:75], v[116:119], v[52:55]
    s_waitcnt vmcnt(9) lgkmcnt(0)
    s_barrier
    v_mfma_f32_16x16x32_bf16 v[16:19], v[76:79], v[120:123], v[16:19]
    ds_read_b128 v[56:59], v4 offset:40960
    v_mfma_f32_16x16x32_bf16 v[36:39], v[76:79], v[124:127], v[36:39]
    ds_read_b128 v[60:63], v4 offset:41984
    v_mfma_f32_16x16x32_bf16 v[20:23], v[80:83], v[120:123], v[20:23]
    ds_read_b128 v[64:67], v4 offset:43008
    v_mfma_f32_16x16x32_bf16 v[40:43], v[80:83], v[124:127], v[40:43]
    ds_read_b128 v[68:71], v4 offset:44032
    v_mfma_f32_16x16x32_bf16 v[24:27], v[84:87], v[120:123], v[24:27]
    ds_read_b128 v[72:75], v4 offset:45056
    v_mfma_f32_16x16x32_bf16 v[44:47], v[84:87], v[124:127], v[44:47]
    v_mfma_f32_16x16x32_bf16 v[28:31], v[88:91], v[120:123], v[28:31]
    v_mfma_f32_16x16x32_bf16 v[48:51], v[88:91], v[124:127], v[48:51]
    v_mfma_f32_16x16x32_bf16 v[32:35], v[92:95], v[120:123], v[32:35]
    v_mfma_f32_16x16x32_bf16 v[52:55], v[92:95], v[124:127], v[52:55]
    s_waitcnt vmcnt(0) lgkmcnt(0)
    v_cmp_ne_u32 vcc, 1, v12
    s_cbranch_vccz LF_p6d
LF_p6:
    global_load_dword v12, v8, s[42:43] sc1
    s_waitcnt vmcnt(0)
    v_cmp_ne_u32 vcc, 1, v12
    s_cbranch_vccz LF_p6d
    s_sleep 1
    s_branch LF_p6
LF_p6d:
    v_mfma_f32_16x16x32_bf16 v[16:19], v[56:59], v[128:131], v[16:19]
    ds_read_b128 v[76:79], v4 offset:51200
    v_mfma_f32_16x16x32_bf16 v[36:39], v[56:59], v[132:135], v[36:39]
    ds_read_b128 v[80:83], v4 offset:52224
    v_mfma_f32_16x16x32_bf16 v[20:23], v[60:63], v[128:131], v[20:23]
    ds_read_b128 v[84:87], v4 offset:53248
    v_mfma_f32_16x16x32_bf16 v[40:43], v[60:63], v[132:135], v[40:43]
    ds_read_b128 v[88:91], v4 offset:54272
    ds_read_b128 v[92:95], v4 offset:55296
    v_mfma_f32_16x16x32_bf16 v[24:27], v[64:67], v[128:131], v[24:27]
    buffer_load_dwordx4 v[160:163], v10, s[48:51], s23 offen sc1
    v_mfma_f32_16x16x32_bf16 v[44:47], v[64:67], v[132:135], v[44:47]
    buffer_load_dwordx4 v[164:167], v10, s[48:51], s24 offen sc1
    v_mfma_f32_16x16x32_bf16 v[28:31], v[68:71], v[128:131], v[28:31]
    s_add_u32 s23, s23, 3072
    s_add_u32 s24, s24, 3072
    v_mfma_f32_16x16x32_bf16 v[48:51], v[68:71], v[132:135], v[48:51]
    buffer_load_dwordx4 v[168:171], v10, s[48:51], s23 offen sc1
    v_mfma_f32_16x16x32_bf16 v[32:35], v[72:75], v[128:131], v[32:35]
    buffer_load_dwordx4 v[172:175], v10, s[48:51], s24 offen sc1
    v_mfma_f32_16x16x32_bf16 v[52:55], v[72:75], v[132:135], v[52:55]
    s_add_u32 s23, s23, 3072
    s_add_u32 s24, s24, 3072
    s_waitcnt vmcnt(9) lgkmcnt(0)
    v_mfma_f32_16x16x32_bf16 v[16:19], v[76:79], v[136:139], v[16:19]
    ds_read_b128 v[56:59], v5 offset:0
    v_mfma_f32_16x16x32_bf16 v[36:39], v[76:79], v[140:143], v[36:39]
    ds_read_b128 v[60:63], v5 offset:1024
    v_mfma_f32_16x16x32_bf16 v[20:23], v[80:83], v[136:139], v[20:23]
    ds_read_b128 v[64:67], v5 offset:2048
    v_mfma_f32_16x16x32_bf16 v[40:43], v[80:83], v[140:143], v[40:43]
    ds_read_b128 v[68:71], v5 offset:3072
    ds_read_b128 v[72:75], v5 offset:4096
    v_mfma_f32_16x16x32_bf16 v[24:27], v[84:87], v[136:139], v[24:27]
    buffer_load_dwordx4 v[176:179], v10, s[48:51], s23 offen sc1
    v_mfma_f32_16x16x32_bf16 v[44:47], v[84:87], v[140:143], v[44:47]
    buffer_load_dwordx4 v[180:183], v10, s[48:51], s24 offen sc1
    v_mfma_f32_16x16x32_bf16 v[28:31], v[88:91], v[136:139], v[28:31]
    s_add_u32 s23, s23, 3072
    s_add_u32 s24, s24, 3072
    v_mfma_f32_16x16x32_bf16 v[48:51], v[88:91], v[140:143], v[48:51]
    buffer_load_dwordx4 v[184:187], v10, s[48:51], s23 offen sc1
    v_mfma_f32_16x16x32_bf16 v[32:35], v[92:95], v[136:139], v[32:35]
    buffer_load_dwordx4 v[188:191], v10, s[48:51], s24 offen sc1
    v_mfma_f32_16x16x32_bf16 v[52:55], v[92:95], v[140:143], v[52:55]
    s_add_u32 s23, s23, 3072
    s_add_u32 s24, s24, 3072
    s_waitcnt vmcnt(11) lgkmcnt(0)
    v_mfma_f32_16x16x32_bf16 v[16:19], v[56:59], v[144:147], v[16:19]
    ds_read_b128 v[76:79], v5 offset:10240
    v_mfma_f32_16x16x32_bf16 v[36:39], v[56:59], v[148:151], v[36:39]
    ds_read_b128 v[80:83], v5 offset:11264
    v_mfma_f32_16x16x32_bf16 v[20:23], v[60:63], v[144:147], v[20:23]
    ds_read_b128 v[84:87], v5 offset:12288
    v_mfma_f32_16x16x32_bf16 v[40:43], v[60:63], v[148:151], v[40:43]
    ds_read_b128 v[88:91], v5 offset:13312
    v_mfma_f32_16x16x32_bf16 v[24:27], v[64:67], v[144:147], v[24:27]
    ds_read_b128 v[92:95], v5 offset:14336
    v_mfma_f32_16x16x32_bf16 v[44:47], v[64:67], v[148:151], v[44:47]
    buffer_load_dwordx4 v[192:195], v10, s[48:51], s23 offen sc1
    v_mfma_f32_16x16x32_bf16 v[28:31], v[68:71], v[144:147], v[28:31]
    buffer_load_dwordx4 v[196:199], v10, s[48:51], s24 offen sc1
    v_mfma_f32_16x16x32_bf16 v[48:51], v[68:71], v[148:151], v[48:51]
    s_add_u32 s23, s23, 3072
    v_mfma_f32_16x16x32_bf16 v[32:35], v[72:75], v[144:147], v[32:35]
    s_add_u32 s24, s24, 3072
    v_mfma_f32_16x16x32_bf16 v[52:55], v[72:75], v[148:151], v[52:55]
    s_waitcnt vmcnt(11) lgkmcnt(0)
    v_mfma_f32_16x16x32_bf16 v[16:19], v[76:79], v[152:155], v[16:19]
    ds_read_b128 v[56:59], v5 offset:20480
    v_mfma_f32_16x16x32_bf16 v[36:39], v[76:79], v[156:159], v[36:39]
    ds_read_b128 v[60:63], v5 offset:21504
    v_mfma_f32_16x16x32_bf16 v[20:23], v[80:83], v[152:155], v[20:23]
    ds_read_b128 v[64:67], v5 offset:22528
    v_mfma_f32_16x16x32_bf16 v[40:43], v[80:83], v[156:159], v[40:43]
    ds_read_b128 v[68:71], v5 offset:23552
    v_mfma_f32_16x16x32_bf16 v[24:27], v[84:87], v[152:155], v[24:27]
    ds_read_b128 v[72:75], v5 offset:24576
    v_mfma_f32_16x16x32_bf16 v[44:47], v[84:87], v[156:159], v[44:47]
    buffer_load_dwordx4 v[200:203], v10, s[48:51], s23 offen sc1
    v_mfma_f32_16x16x32_bf16 v[28:31], v[88:91], v[152:155], v[28:31]
    buffer_load_dwordx4 v[204:207], v10, s[48:51], s24 offen sc1
    v_mfma_f32_16x16x32_bf16 v[48:51], v[88:91], v[156:159], v[48:51]
    s_add_u32 s23, s23, 3072
    v_mfma_f32_16x16x32_bf16 v[32:35], v[92:95], v[152:155], v[32:35]
    s_add_u32 s24, s24, 3072
    v_mfma_f32_16x16x32_bf16 v[52:55], v[92:95], v[156:159], v[52:55]
    s_waitcnt vmcnt(10) lgkmcnt(0)
    v_mfma_f32_16x16x32_bf16 v[16:19], v[56:59], v[160:163], v[16:19]
    ds_read_b128 v[76:79], v5 offset:30720
    v_mfma_f32_16x16x32_bf16 v[36:39], v[56:59], v[164:167], v[36:39]
    ds_read_b128 v[80:83], v5 offset:31744
    v_mfma_f32_16x16x32_bf16 v[20:23], v[60:63], v[160:163], v[20:23]
    ds_read_b128 v[84:87], v5 offset:32768
    v_mfma_f32_16x16x32_bf16 v[40:43], v[60:63], v[164:167], v[40:43]
    ds_read_b128 v[88:91], v5 offset:33792
    v_mfma_f32_16x16x32_bf16 v[24:27], v[64:67], v[160:163], v[24:27]
    ds_read_b128 v[92:95], v5 offset:34816
    v_mfma_f32_16x16x32_bf16 v[44:47], v[64:67], v[164:167], v[44:47]
    buffer_load_dwordx4 v[208:211], v10, s[48:51], s23 offen sc1
    v_mfma_f32_16x16x32_bf16 v[28:31], v[68:71], v[160:163], v[28:31]
    buffer_load_dwordx4 v[212:215], v10, s[48:51], s24 offen sc1
    v_mfma_f32_16x16x32_bf16 v[48:51], v[68:71], v[164:167], v[48:51]
    s_add_u32 s23, s23, 3072
    v_mfma_f32_16x16x32_bf16 v[32:35], v[72:75], v[160:163], v[32:35]
    s_add_u32 s24, s24, 3072
    v_mfma_f32_16x16x32_bf16 v[52:55], v[72:75], v[164:167], v[52:55]
    s_waitcnt vmcnt(10) lgkmcnt(0)
    s_barrier
    v_mfma_f32_16x16x32_bf16 v[16:19], v[76:79], v[168:171], v[16:19]
    ds_read_b128 v[56:59], v5 offset:40960
    v_mfma_f32_16x16x32_bf16 v[36:39], v[76:79], v[172:175], v[36:39]
    ds_read_b128 v[60:63], v5 offset:41984
    v_mfma_f32_16x16x32_bf16 v[20:23], v[80:83], v[168:171], v[20:23]
    ds_read_b128 v[64:67], v5 offset:43008
    v_mfma_f32_16x16x32_bf16 v[40:43], v[80:83], v[172:175], v[40:43]
    ds_read_b128 v[68:71], v5 offset:44032
    v_mfma_f32_16x16x32_bf16 v[24:27], v[84:87], v[168:171], v[24:27]
    ds_read_b128 v[72:75], v5 offset:45056
    v_mfma_f32_16x16x32_bf16 v[44:47], v[84:87], v[172:175], v[44:47]
    buffer_load_dwordx4 v[216:219], v10, s[48:51], s23 offen sc1
    v_mfma_f32_16x16x32_bf16 v[28:31], v[88:91], v[168:171], v[28:31]
    buffer_load_dwordx4 v[220:223], v10, s[48:51], s24 offen sc1
    v_mfma_f32_16x16x32_bf16 v[48:51], v[88:91], v[172:175], v[48:51]
    s_add_u32 s23, s23, 3072
    v_mfma_f32_16x16x32_bf16 v[32:35], v[92:95], v[168:171], v[32:35]
    s_add_u32 s24, s24, 3072
    v_mfma_f32_16x16x32_bf16 v[52:55], v[92:95], v[172:175], v[52:55]
    s_waitcnt vmcnt(10) lgkmcnt(0)
    v_mfma_f32_16x16x32_bf16 v[16:19], v[56:59], v[176:179], v[16:19]
    ds_read_b128 v[76:79], v5 offset:51200
    v_mfma_f32_16x16x32_bf16 v[36:39], v[56:59], v[180:183], v[36:39]
    ds_read_b128 v[80:83], v5 offset:52224
    v_mfma_f32_16x16x32_bf16 v[20:23], v[60:63], v[176:179], v[20:23]
    ds_read_b128 v[84:87], v5 offset:53248
    v_mfma_f32_16x16x32_bf16 v[40:43], v[60:63], v[180:183], v[40:43]
    ds_read_b128 v[88:91], v5 offset:54272
    v_mfma_f32_16x16x32_bf16 v[24:27], v[64:67], v[176:179], v[24:27]
    ds_read_b128 v[92:95], v5 offset:55296
    v_mfma_f32_16x16x32_bf16 v[44:47], v[64:67], v[180:183], v[44:47]
    buffer_load_dwordx4 v[224:227], v10, s[48:51], s23 offen sc1
    v_mfma_f32_16x16x32_bf16 v[28:31], v[68:71], v[176:179], v[28:31]
    buffer_load_dwordx4 v[228:231], v10, s[48:51], s24 offen sc1
    v_mfma_f32_16x16x32_bf16 v[48:51], v[68:71], v[180:183], v[48:51]
    s_add_u32 s23, s23, 3072
    v_mfma_f32_16x16x32_bf16 v[32:35], v[72:75], v[176:179], v[32:35]
    s_add_u32 s24, s24, 3072
    v_mfma_f32_16x16x32_bf16 v[52:55], v[72:75], v[180:183], v[52:55]
    s_waitcnt vmcnt(10) lgkmcnt(0)
    v_mfma_f32_16x16x32_bf16 v[16:19], v[76:79], v[184:187], v[16:19]
    ds_read_b128 v[56:59], v6 offset:0
    v_mfma_f32_16x16x32_bf16 v[36:39], v[76:79], v[188:191], v[36:39]
    ds_read_b128 v[60:63], v6 offset:1024
    v_mfma_f32_16x16x32_bf16 v[20:23], v[80:83], v[184:187], v[20:23]
    ds_read_b128 v[64:67], v6 offset:2048
    v_mfma_f32_16x16x32_bf16 v[40:43], v[80:83], v[188:191], v[40:43]
    ds_read_b128 v[68:71], v6 offset:3072
    v_mfma_f32_16x16x32_bf16 v[24:27], v[84:87], v[184:187], v[24:27]
    ds_read_b128 v[72:75], v6 offset:4096
    v_mfma_f32_16x16x32_bf16 v[44:47], v[84:87], v[188:191], v[44:47]
    buffer_load_dwordx4 v[232:235], v10, s[48:51], s23 offen sc1
    v_mfma_f32_16x16x32_bf16 v[28:31], v[88:91], v[184:187], v[28:31]
    buffer_load_dwordx4 v[236:239], v10, s[48:51], s24 offen sc1
    v_mfma_f32_16x16x32_bf16 v[48:51], v[88:91], v[188:191], v[48:51]
    s_add_u32 s23, s23, 3072
    v_mfma_f32_16x16x32_bf16 v[32:35], v[92:95], v[184:187], v[32:35]
    s_add_u32 s24, s24, 3072
    v_mfma_f32_16x16x32_bf16 v[52:55], v[92:95], v[188:191], v[52:55]
    s_waitcnt vmcnt(10) lgkmcnt(0)
    v_mfma_f32_16x16x32_bf16 v[16:19], v[56:59], v[192:195], v[16:19]
    ds_read_b128 v[76:79], v6 offset:10240
    v_mfma_f32_16x16x32_bf16 v[36:39], v[56:59], v[196:199], v[36:39]
    ds_read_b128 v[80:83], v6 offset:11264
    v_mfma_f32_16x16x32_bf16 v[20:23], v[60:63], v[192:195], v[20:23]
    ds_read_b128 v[84:87], v6 offset:12288
    v_mfma_f32_16x16x32_bf16 v[40:43], v[60:63], v[196:199], v[40:43]
    ds_read_b128 v[88:91], v6 offset:13312
    v_mfma_f32_16x16x32_bf16 v[24:27], v[64:67], v[192:195], v[24:27]
    ds_read_b128 v[92:95], v6 offset:14336
    v_mfma_f32_16x16x32_bf16 v[44:47], v[64:67], v[196:199], v[44:47]
    buffer_load_dwordx4 v[240:243], v10, s[48:51], s23 offen sc1
    v_mfma_f32_16x16x32_bf16 v[28:31], v[68:71], v[192:195], v[28:31]
    buffer_load_dwordx4 v[244:247], v10, s[48:51], s24 offen sc1
    v_mfma_f32_16x16x32_bf16 v[48:51], v[68:71], v[196:199], v[48:51]
    s_add_u32 s23, s23, 3072
    v_mfma_f32_16x16x32_bf16 v[32:35], v[72:75], v[192:195], v[32:35]
    s_add_u32 s24, s24, 3072
    v_mfma_f32_16x16x32_bf16 v[52:55], v[72:75], v[196:199], v[52:55]
    s_waitcnt vmcnt(10) lgkmcnt(0)
    v_mfma_f32_16x16x32_bf16 v[16:19], v[76:79], v[200:203], v[16:19]
    ds_read_b128 v[56:59], v4 offset:0
    v_mfma_f32_16x16x32_bf16 v[36:39], v[76:79], v[204:207], v[36:39]
    ds_read_b128 v[60:63], v4 offset:1024
    v_mfma_f32_16x16x32_bf16 v[20:23], v[80:83], v[200:203], v[20:23]
    ds_read_b128 v[64:67], v4 offset:2048
    v_mfma_f32_16x16x32_bf16 v[40:43], v[80:83], v[204:207], v[40:43]
    ds_read_b128 v[68:71], v4 offset:3072
    v_mfma_f32_16x16x32_bf16 v[24:27], v[84:87], v[200:203], v[24:27]
    ds_read_b128 v[72:75], v4 offset:4096
    v_mfma_f32_16x16x32_bf16 v[44:47], v[84:87], v[204:207], v[44:47]
    buffer_load_dwordx4 v[248:251], v10, s[48:51], s23 offen sc1
    v_mfma_f32_16x16x32_bf16 v[28:31], v[88:91], v[200:203], v[28:31]
    buffer_load_dwordx4 v[252:255], v10, s[48:51], s24 offen sc1
    v_mfma_f32_16x16x32_bf16 v[48:51], v[88:91], v[204:207], v[48:51]
    s_add_u32 s23, s23, 3072
    v_mfma_f32_16x16x32_bf16 v[32:35], v[92:95], v[200:203], v[32:35]
    s_add_u32 s24, s24, 3072
    v_mfma_f32_16x16x32_bf16 v[52:55], v[92:95], v[204:207], v[52:55]
    s_waitcnt vmcnt(10) lgkmcnt(0)
    v_mfma_f32_16x16x32_bf16 v[16:19], v[56:59], v[208:211], v[16:19]
    ds_read_b128 v[76:79], v4 offset:10240
    v_mfma_f32_16x16x32_bf16 v[36:39], v[56:59], v[212:215], v[36:39]
    ds_read_b128 v[80:83], v4 offset:11264
    v_mfma_f32_16x16x32_bf16 v[20:23], v[60:63], v[208:211], v[20:23]
    ds_read_b128 v[84:87], v4 offset:12288
    v_mfma_f32_16x16x32_bf16 v[40:43], v[60:63], v[212:215], v[40:43]
    ds_read_b128 v[88:91], v4 offset:13312
    v_mfma_f32_16x16x32_bf16 v[24:27], v[64:67], v[208:211], v[24:27]
    ds_read_b128 v[92:95], v4 offset:14336
    v_mfma_f32_16x16x32_bf16 v[44:47], v[64:67], v[212:215], v[44:47]
    buffer_load_dwordx4 v[96:99], v10, s[48:51], s23 offen sc1
    v_mfma_f32_16x16x32_bf16 v[28:31], v[68:71], v[208:211], v[28:31]
    buffer_load_dwordx4 v[100:103], v10, s[48:51], s24 offen sc1
    v_mfma_f32_16x16x32_bf16 v[48:51], v[68:71], v[212:215], v[48:51]
    s_add_u32 s23, s23, 3072
    v_mfma_f32_16x16x32_bf16 v[32:35], v[72:75], v[208:211], v[32:35]
    s_add_u32 s24, s24, 3072
    v_mfma_f32_16x16x32_bf16 v[52:55], v[72:75], v[212:215], v[52:55]
    s_waitcnt vmcnt(10) lgkmcnt(0)
    s_barrier
    v_mfma_f32_16x16x32_bf16 v[16:19], v[76:79], v[216:219], v[16:19]
    ds_read_b128 v[56:59], v4 offset:20480
    v_mfma_f32_16x16x32_bf16 v[36:39], v[76:79], v[220:223], v[36:39]
    ds_read_b128 v[60:63], v4 offset:21504
    v_mfma_f32_16x16x32_bf16 v[20:23], v[80:83], v[216:219], v[20:23]
    ds_read_b128 v[64:67], v4 offset:22528
    v_mfma_f32_16x16x32_bf16 v[40:43], v[80:83], v[220:223], v[40:43]
    ds_read_b128 v[68:71], v4 offset:23552
    v_mfma_f32_16x16x32_bf16 v[24:27], v[84:87], v[216:219], v[24:27]
    ds_read_b128 v[72:75], v4 offset:24576
    v_mfma_f32_16x16x32_bf16 v[44:47], v[84:87], v[220:223], v[44:47]
    buffer_load_dwordx4 v[104:107], v10, s[48:51], s23 offen sc1
    v_mfma_f32_16x16x32_bf16 v[28:31], v[88:91], v[216:219], v[28:31]
    buffer_load_dwordx4 v[108:111], v10, s[48:51], s24 offen sc1
    v_mfma_f32_16x16x32_bf16 v[48:51], v[88:91], v[220:223], v[48:51]
    s_add_u32 s23, s23, 3072
    v_mfma_f32_16x16x32_bf16 v[32:35], v[92:95], v[216:219], v[32:35]
    s_add_u32 s24, s24, 3072
    v_mfma_f32_16x16x32_bf16 v[52:55], v[92:95], v[220:223], v[52:55]
    s_waitcnt vmcnt(10) lgkmcnt(0)
    v_mfma_f32_16x16x32_bf16 v[16:19], v[56:59], v[224:227], v[16:19]
    ds_read_b128 v[76:79], v4 offset:30720
    v_mfma_f32_16x16x32_bf16 v[36:39], v[56:59], v[228:231], v[36:39]
    ds_read_b128 v[80:83], v4 offset:31744
    v_mfma_f32_16x16x32_bf16 v[20:23], v[60:63], v[224:227], v[20:23]
    ds_read_b128 v[84:87], v4 offset:32768
    v_mfma_f32_16x16x32_bf16 v[40:43], v[60:63], v[228:231], v[40:43]
    ds_read_b128 v[88:91], v4 offset:33792
    v_mfma_f32_16x16x32_bf16 v[24:27], v[64:67], v[224:227], v[24:27]
    ds_read_b128 v[92:95], v4 offset:34816
    v_mfma_f32_16x16x32_bf16 v[44:47], v[64:67], v[228:231], v[44:47]
    buffer_load_dwordx4 v[112:115], v10, s[48:51], s23 offen sc1
    v_mfma_f32_16x16x32_bf16 v[28:31], v[68:71], v[224:227], v[28:31]
    buffer_load_dwordx4 v[116:119], v10, s[48:51], s24 offen sc1
    v_mfma_f32_16x16x32_bf16 v[48:51], v[68:71], v[228:231], v[48:51]
    s_add_u32 s23, s23, 3072
    v_mfma_f32_16x16x32_bf16 v[32:35], v[72:75], v[224:227], v[32:35]
    s_add_u32 s24, s24, 3072
    v_mfma_f32_16x16x32_bf16 v[52:55], v[72:75], v[228:231], v[52:55]
    s_waitcnt vmcnt(10) lgkmcnt(0)
    v_mfma_f32_16x16x32_bf16 v[16:19], v[76:79], v[232:235], v[16:19]
    ds_read_b128 v[56:59], v4 offset:40960
    v_mfma_f32_16x16x32_bf16 v[36:39], v[76:79], v[236:239], v[36:39]
    ds_read_b128 v[60:63], v4 offset:41984
    v_mfma_f32_16x16x32_bf16 v[20:23], v[80:83], v[232:235], v[20:23]
    ds_read_b128 v[64:67], v4 offset:43008
    v_mfma_f32_16x16x32_bf16 v[40:43], v[80:83], v[236:239], v[40:43]
    ds_read_b128 v[68:71], v4 offset:44032
    v_mfma_f32_16x16x32_bf16 v[24:27], v[84:87], v[232:235], v[24:27]
    ds_read_b128 v[72:75], v4 offset:45056
    v_mfma_f32_16x16x32_bf16 v[44:47], v[84:87], v[236:239], v[44:47]
    buffer_load_dwordx4 v[120:123], v10, s[48:51], s23 offen sc1
    v_mfma_f32_16x16x32_bf16 v[28:31], v[88:91], v[232:235], v[28:31]
    buffer_load_dwordx4 v[124:127], v10, s[48:51], s24 offen sc1
    v_mfma_f32_16x16x32_bf16 v[48:51], v[88:91], v[236:239], v[48:51]
    s_add_u32 s23, s23, 3072
    v_mfma_f32_16x16x32_bf16 v[32:35], v[92:95], v[232:235], v[32:35]
    s_add_u32 s24, s24, 3072
    v_mfma_f32_16x16x32_bf16 v[52:55], v[92:95], v[236:239], v[52:55]
    s_waitcnt vmcnt(10) lgkmcnt(0)
    v_mfma_f32_16x16x32_bf16 v[16:19], v[56:59], v[240:243], v[16:19]
    ds_read_b128 v[76:79], v4 offset:51200
    v_mfma_f32_16x16x32_bf16 v[36:39], v[56:59], v[244:247], v[36:39]
    ds_read_b128 v[80:83], v4 offset:52224
    v_mfma_f32_16x16x32_bf16 v[20:23], v[60:63], v[240:243], v[20:23]
    ds_read_b128 v[84:87], v4 offset:53248
    v_mfma_f32_16x16x32_bf16 v[40:43], v[60:63], v[244:247], v[40:43]
    ds_read_b128 v[88:91], v4 offset:54272
    v_mfma_f32_16x16x32_bf16 v[24:27], v[64:67], v[240:243], v[24:27]
    ds_read_b128 v[92:95], v4 offset:55296
    v_mfma_f32_16x16x32_bf16 v[44:47], v[64:67], v[244:247], v[44:47]
    v_mfma_f32_16x16x32_bf16 v[28:31], v[68:71], v[240:243], v[28:31]
    v_mfma_f32_16x16x32_bf16 v[48:51], v[68:71], v[244:247], v[48:51]
    v_mfma_f32_16x16x32_bf16 v[32:35], v[72:75], v[240:243], v[32:35]
    v_mfma_f32_16x16x32_bf16 v[52:55], v[72:75], v[244:247], v[52:55]
    s_waitcnt vmcnt(8) lgkmcnt(0)
    v_mfma_f32_16x16x32_bf16 v[16:19], v[76:79], v[248:251], v[16:19]
    ds_read_b128 v[56:59], v5 offset:0
    v_mfma_f32_16x16x32_bf16 v[36:39], v[76:79], v[252:255], v[36:39]
    ds_read_b128 v[60:63], v5 offset:1024
    v_mfma_f32_16x16x32_bf16 v[20:23], v[80:83], v[248:251], v[20:23]
    ds_read_b128 v[64:67], v5 offset:2048
    v_mfma_f32_16x16x32_bf16 v[40:43], v[80:83], v[252:255], v[40:43]
    ds_read_b128 v[68:71], v5 offset:3072
    v_mfma_f32_16x16x32_bf16 v[24:27], v[84:87], v[248:251], v[24:27]
    ds_read_b128 v[72:75], v5 offset:4096
    v_mfma_f32_16x16x32_bf16 v[44:47], v[84:87], v[252:255], v[44:47]
    v_mfma_f32_16x16x32_bf16 v[28:31], v[88:91], v[248:251], v[28:31]
    v_mfma_f32_16x16x32_bf16 v[48:51], v[88:91], v[252:255], v[48:51]
    v_mfma_f32_16x16x32_bf16 v[32:35], v[92:95], v[248:251], v[32:35]
    v_mfma_f32_16x16x32_bf16 v[52:55], v[92:95], v[252:255], v[52:55]
    s_waitcnt vmcnt(6) lgkmcnt(0)
    v_mfma_f32_16x16x32_bf16 v[16:19], v[56:59], v[96:99], v[16:19]
    ds_read_b128 v[76:79], v5 offset:10240
    v_mfma_f32_16x16x32_bf16 v[36:39], v[56:59], v[100:103], v[36:39]
    ds_read_b128 v[80:83], v5 offset:11264
    v_mfma_f32_16x16x32_bf16 v[20:23], v[60:63], v[96:99], v[20:23]
    ds_read_b128 v[84:87], v5 offset:12288
    v_mfma_f32_16x16x32_bf16 v[40:43], v[60:63], v[100:103], v[40:43]
    ds_read_b128 v[88:91], v5 offset:13312
    v_mfma_f32_16x16x32_bf16 v[24:27], v[64:67], v[96:99], v[24:27]
    ds_read_b128 v[92:95], v5 offset:14336
    v_mfma_f32_16x16x32_bf16 v[44:47], v[64:67], v[100:103], v[44:47]
    v_mfma_f32_16x16x32_bf16 v[28:31], v[68:71], v[96:99], v[28:31]
    v_mfma_f32_16x16x32_bf16 v[48:51], v[68:71], v[100:103], v[48:51]
    v_mfma_f32_16x16x32_bf16 v[32:35], v[72:75], v[96:99], v[32:35]
    v_mfma_f32_16x16x32_bf16 v[52:55], v[72:75], v[100:103], v[52:55]
    s_waitcnt vmcnt(4) lgkmcnt(0)
    v_mfma_f32_16x16x32_bf16 v[16:19], v[76:79], v[104:107], v[16:19]
    ds_read_b128 v[56:59], v5 offset:20480
    v_mfma_f32_16x16x32_bf16 v[36:39], v[76:79], v[108:111], v[36:39]
    ds_read_b128 v[60:63], v5 offset:21504
    v_mfma_f32_16x16x32_bf16 v[20:23], v[80:83], v[104:107], v[20:23]
    ds_read_b128 v[64:67], v5 offset:22528
    v_mfma_f32_16x16x32_bf16 v[40:43], v[80:83], v[108:111], v[40:43]
    ds_read_b128 v[68:71], v5 offset:23552
    v_mfma_f32_16x16x32_bf16 v[24:27], v[84:87], v[104:107], v[24:27]
    ds_read_b128 v[72:75], v5 offset:24576
    v_mfma_f32_16x16x32_bf16 v[44:47], v[84:87], v[108:111], v[44:47]
    v_mfma_f32_16x16x32_bf16 v[28:31], v[88:91], v[104:107], v[28:31]
    v_mfma_f32_16x16x32_bf16 v[48:51], v[88:91], v[108:111], v[48:51]
    v_mfma_f32_16x16x32_bf16 v[32:35], v[92:95], v[104:107], v[32:35]
    v_mfma_f32_16x16x32_bf16 v[52:55], v[92:95], v[108:111], v[52:55]
    s_waitcnt vmcnt(2) lgkmcnt(0)
    v_mfma_f32_16x16x32_bf16 v[16:19], v[56:59], v[112:115], v[16:19]
    ds_read_b128 v[76:79], v5 offset:30720
    v_mfma_f32_16x16x32_bf16 v[36:39], v[56:59], v[116:119], v[36:39]
    ds_read_b128 v[80:83], v5 offset:31744
    v_mfma_f32_16x16x32_bf16 v[20:23], v[60:63], v[112:115], v[20:23]
    ds_read_b128 v[84:87], v5 offset:32768
    v_mfma_f32_16x16x32_bf16 v[40:43], v[60:63], v[116:119], v[40:43]
    ds_read_b128 v[88:91], v5 offset:33792
    v_mfma_f32_16x16x32_bf16 v[24:27], v[64:67], v[112:115], v[24:27]
    ds_read_b128 v[92:95], v5 offset:34816
    v_mfma_f32_16x16x32_bf16 v[44:47], v[64:67], v[116:119], v[44:47]
    ds_read_b64_tr_b16 v[240:241], v2 offset:0
    v_mfma_f32_16x16x32_bf16 v[28:31], v[68:71], v[112:115], v[28:31]
    ds_read_b64_tr_b16 v[242:243], v2 offset:2048
    v_mfma_f32_16x16x32_bf16 v[48:51], v[68:71], v[116:119], v[48:51]
    ds_read_b64_tr_b16 v[244:245], v2 offset:4096
    v_mfma_f32_16x16x32_bf16 v[32:35], v[72:75], v[112:115], v[32:35]
    ds_read_b64_tr_b16 v[246:247], v2 offset:6144
    v_mfma_f32_16x16x32_bf16 v[52:55], v[72:75], v[116:119], v[52:55]
    ds_read_b64_tr_b16 v[248:249], v2 offset:8192
    s_waitcnt vmcnt(0) lgkmcnt(0)
    v_mfma_f32_16x16x32_bf16 v[16:19], v[76:79], v[120:123], v[16:19]
    v_mfma_f32_16x16x32_bf16 v[36:39], v[76:79], v[124:127], v[36:39]
    v_mfma_f32_16x16x32_bf16 v[20:23], v[80:83], v[120:123], v[20:23]
    v_mfma_f32_16x16x32_bf16 v[40:43], v[80:83], v[124:127], v[40:43]
    v_mfma_f32_16x16x32_bf16 v[24:27], v[84:87], v[120:123], v[24:27]
    v_mfma_f32_16x16x32_bf16 v[44:47], v[84:87], v[124:127], v[44:47]
    v_mfma_f32_16x16x32_bf16 v[28:31], v[88:91], v[120:123], v[28:31]
    v_mfma_f32_16x16x32_bf16 v[48:51], v[88:91], v[124:127], v[48:51]
    v_mfma_f32_16x16x32_bf16 v[32:35], v[92:95], v[120:123], v[32:35]
    v_mfma_f32_16x16x32_bf16 v[52:55], v[92:95], v[124:127], v[52:55]
LF_fin:
    s_cmp_eq_u32 s8, 0
    s_cbranch_scc1 LF_x0
    ds_write_b128 v14, v[16:19] offset:0
    ds_write_b128 v14, v[20:23] offset:1024
    ds_write_b128 v14, v[24:27] offset:2048
    ds_write_b128 v14, v[28:31] offset:3072
    s_nop 0
    ds_write_b128 v14, v[32:35] offset:4096
    v_mov_b64 v[16:17], v[36:37]
    v_mov_b64 v[18:19], v[38:39]
    v_mov_b64 v[20:21], v[40:41]
    v_mov_b64 v[22:23], v[42:43]
    v_mov_b64 v[24:25], v[44:45]
    v_mov_b64 v[26:27], v[46:47]
    v_mov_b64 v[28:29], v[48:49]
    v_mov_b64 v[30:31], v[50:51]
    v_mov_b64 v[32:33], v[52:53]
    v_mov_b64 v[34:35], v[54:55]
    s_branch LF_x1
LF_x0:
    ds_write_b128 v14, v[36:39] offset:0
    ds_write_b128 v14, v[40:43] offset:1024
    ds_write_b128 v14, v[44:47] offset:2048
    s_nop 0
    ds_write_b128 v14, v[48:51] offset:3072
    s_nop 0
    ds_write_b128 v14, v[52:55] offset:4096
LF_x1:
    v_lshlrev_b32 v112, 16, v240
    v_and_b32 v113, 0xffff0000, v240
    v_lshlrev_b32 v114, 16, v241
    v_and_b32 v115, 0xffff0000, v241
    v_pk_add_f32 v[16:17], v[16:17], v[112:113]
    v_pk_add_f32 v[18:19], v[18:19], v[114:115]
    v_lshlrev_b32 v116, 16, v242
    v_and_b32 v117, 0xffff0000, v242
    v_lshlrev_b32 v118, 16, v243
    v_and_b32 v119, 0xffff0000, v243
    v_pk_add_f32 v[20:21], v[20:21], v[116:117]
    v_pk_add_f32 v[22:23], v[22:23], v[118:119]
    v_lshlrev_b32 v120, 16, v244
    v_and_b32 v121, 0xffff0000, v244
    v_lshlrev_b32 v122, 16, v245
    v_and_b32 v123, 0xffff0000, v245
    v_pk_add_f32 v[24:25], v[24:25], v[120:121]
    v_pk_add_f32 v[26:27], v[26:27], v[122:123]
    v_lshlrev_b32 v124, 16, v246
    v_and_b32 v125, 0xffff0000, v246
    v_lshlrev_b32 v126, 16, v247
    v_and_b32 v127, 0xffff0000, v247
    v_pk_add_f32 v[28:29], v[28:29], v[124:125]
    v_pk_add_f32 v[30:31], v[30:31], v[126:127]
    v_lshlrev_b32 v128, 16, v248
    v_and_b32 v129, 0xffff0000, v248
    v_lshlrev_b32 v130, 16, v249
    v_and_b32 v131, 0xffff0000, v249
    v_pk_add_f32 v[32:33], v[32:33], v[128:129]
    v_pk_add_f32 v[34:35], v[34:35], v[130:131]
    s_waitcnt lgkmcnt(0)
    s_barrier
LF_fb:
    ds_read_b128 v[64:67], v15 offset:0
    ds_read_b128 v[68:71], v15 offset:1024
    ds_read_b128 v[72:75], v15 offset:2048
    ds_read_b128 v[76:79], v15 offset:3072
    ds_read_b128 v[80:83], v15 offset:4096
    s_waitcnt lgkmcnt(4)
    v_pk_add_f32 v[16:17], v[16:17], v[64:65]
    v_pk_add_f32 v[18:19], v[18:19], v[66:67]
    v_cvt_pk_bf16_f32 v96, v16, v17
    v_cvt_pk_bf16_f32 v97, v18, v19
    s_waitcnt lgkmcnt(3)
    v_pk_add_f32 v[20:21], v[20:21], v[68:69]
    v_pk_add_f32 v[22:23], v[22:23], v[70:71]
    v_cvt_pk_bf16_f32 v98, v20, v21
    v_cvt_pk_bf16_f32 v99, v22, v23
    s_nop 0
    v_permlane16_swap_b32 v96, v98
    v_permlane16_swap_b32 v97, v99
    s_waitcnt lgkmcnt(2)
    v_pk_add_f32 v[24:25], v[24:25], v[72:73]
    v_pk_add_f32 v[26:27], v[26:27], v[74:75]
    v_cvt_pk_bf16_f32 v100, v24, v25
    v_cvt_pk_bf16_f32 v101, v26, v27
    s_waitcnt lgkmcnt(1)
    v_pk_add_f32 v[28:29], v[28:29], v[76:77]
    v_pk_add_f32 v[30:31], v[30:31], v[78:79]
    v_cvt_pk_bf16_f32 v102, v28, v29
    v_cvt_pk_bf16_f32 v103, v30, v31
    s_nop 0
    v_permlane16_swap_b32 v100, v102
    v_permlane16_swap_b32 v101, v103
    s_waitcnt lgkmcnt(0)
    v_pk_add_f32 v[32:33], v[32:33], v[80:81]
    v_pk_add_f32 v[34:35], v[34:35], v[82:83]
    v_cvt_pk_bf16_f32 v104, v32, v33
    v_cvt_pk_bf16_f32 v105, v34, v35
    global_store_dwordx4 v13, v[96:99], s[38:39] nt
    global_store_dwordx4 v13, v[100:103], s[38:39] offset:64 nt
    global_store_dwordx2 v3, v[104:105], s[38:39] offset:128 nt
L1_end:
    s_endpgm
.section .rodata,"a"
.p2align 6
.amdhsa_kernel sequential_preLN__ssm_conv_s4__glu_gated_swiglu__prompt_kernel
  .amdhsa_next_free_vgpr 256
  .amdhsa_next_free_sgpr 102
  .amdhsa_accum_offset 256
  .amdhsa_group_segment_fixed_size 0
  .amdhsa_kernarg_size 128
  .amdhsa_user_sgpr_count 2
  .amdhsa_user_sgpr_kernarg_segment_ptr 1
  .amdhsa_system_sgpr_workgroup_id_x 1
  .amdhsa_float_denorm_mode_32 3
.end_amdhsa_kernel
```
